```python
import torch

def _softmax(x, axis=-1):
    return torch.softmax(x, dim=axis)
def _gelu(x):
    return torch.nn.functional.gelu(x, approximate="tanh")
def _silu(x):
    return torch.nn.functional.silu(x)
def _sigmoid(x):
    return torch.sigmoid(x)
def _layernorm(x, axis=-1, eps=1e-5):
    m = x.mean(dim=axis, keepdim=True)
    v = x.var(dim=axis, keepdim=True, unbiased=False)
    return (x - m) / torch.sqrt(v + eps)
def _scatter_add(tgt, idx, src, axis=0):
    return tgt.clone().index_add_(axis, idx, src)
def _segment_sum(src, seg, n):
    out = torch.zeros((n,) + src.shape[1:], dtype=src.dtype)
    return out.index_add_(0, seg, src)
def _pad(x, pw):
    flat = tuple(v for pair in reversed(pw) for v in pair)
    return torch.nn.functional.pad(x, flat)

kernel_name = 'parallel_sum__spectral_gfnet__glu_gated_swiglu__prompt'

def setup_inputs():

    _w = (lambda a: (lambda t: t.to(torch.bfloat16) if t.is_floating_point() else t)(torch.as_tensor(a)))
    def _A_setup():
        B, S, D = 1, 2048, 512
        Df = D // 2 + 1
        return {
            "x": _w((lambda *s: torch.randn(*s, dtype=torch.bfloat16) * 0.05)(B, S, D)),
            "w_r": _w((lambda *s: torch.randn(*s, dtype=torch.bfloat16) * 0.4)(S, Df) * 0.02),
            "w_i": _w((lambda *s: torch.randn(*s, dtype=torch.bfloat16) * 0.4)(S, Df) * 0.02),
        }
    _A_in = _A_setup()

    def _B_setup():
        B, S, D, F = 1, 2048, 512, 1376
        return {
            "x": _w((lambda *s: torch.randn(*s, dtype=torch.bfloat16) * 0.05)(B, S, D)),
            "w1": _w((lambda *s: torch.randn(*s, dtype=torch.bfloat16) * 0.2)(D, F) * (2.0 / D) ** 0.5),
            "w3": _w((lambda *s: torch.randn(*s, dtype=torch.bfloat16) * 0.2)(D, F) * (2.0 / D) ** 0.5),
            "w2": _w((lambda *s: torch.randn(*s, dtype=torch.bfloat16) * 0.2)(F, D) * (2.0 / F) ** 0.5),
        }
    _B_in = _B_setup()

    return {
        "A_x": _A_in["x"],
        "A_w_r": _A_in["w_r"],
        "A_w_i": _A_in["w_i"],
        "B_x": _B_in["x"],
        "B_w1": _B_in["w1"],
        "B_w3": _B_in["w3"],
        "B_w2": _B_in["w2"],
    }

def reference(A_x, A_w_r, A_w_i, B_x, B_w1, B_w3, B_w2):
    def _A_ref(x, w_r, w_i):
        B, S, D = x.shape
        X = (lambda x, axes=(-2,-1): torch.fft.rfft2(x.float(), dim=axes))(x, axes=(-2, -1))
        W = w_r + 1j * w_i
        X = X * W
        y = (lambda x, s, axes=(-2,-1): torch.fft.irfft2(x, s=s, dim=axes).to(torch.bfloat16))(X, (S, D), axes=(-2, -1))
        return y

    def _B_ref(x, w1, w3, w2):
        gate = torch.einsum("bsd,df->bsf", x, w1)
        up = torch.einsum("bsd,df->bsf", x, w3)
        h = _silu(gate) * up
        out = torch.einsum("bsf,fd->bsd", h, w2)
        return out

    x = A_x
    xn = _layernorm(x, axis=-1)
    return x + _A_ref(xn, A_w_r, A_w_i) + _B_ref(xn, B_w1, B_w3, B_w2)
```

```asm
; @launch grid=(256,1,1) block=(768,1,1) lds=163840
.amdgcn_target "amdgcn-amd-amdhsa--gfx950"
.text
.globl parallel_sum__spectral_gfnet__glu_gated_swiglu__prompt_kernel
.p2align 8
.type parallel_sum__spectral_gfnet__glu_gated_swiglu__prompt_kernel,@function
parallel_sum__spectral_gfnet__glu_gated_swiglu__prompt_kernel:
    s_cmp_ge_u32 s2, 0x100
    s_cbranch_scc1 Lend_1
    v_lshrrev_b32 v1, 6, v0
    v_and_b32 v0, 63, v0
    v_readfirstlane_b32 s40, v1
    s_nop 0
    s_cmp_lg_u32 s40, 8
    s_cbranch_scc1 Lzs_2
    v_lshlrev_b32 v10, 2, v0
    v_add_u32 v10, 156256, v10
    v_mov_b32 v11, 0
    ds_write_b32 v10, v11
    s_waitcnt lgkmcnt(0)
Lzs_2:
    s_load_dwordx16 s[64:79], s[0:1], 0
    s_load_dwordx4 s[80:83], s[0:1], 64
    s_and_b32 s42, s2, 7
    s_lshr_b32 s43, s2, 3
    s_and_b32 s41, s40, 3
    s_lshr_b32 s45, s40, 2
    s_barrier
    s_cmp_lg_u32 s40, 3
    s_cbranch_scc1 Lpf_6
    s_getpc_b64 s[48:49]
    v_lshlrev_b32 v30, 12, v0
    s_lshl_b32 s47, s43, 7
    v_add_u32 v30, s47, v30
    v_mov_b32 v31, s49
    v_add_co_u32 v30, vcc, s48, v30
    s_nop 1
    v_addc_co_u32 v31, vcc, 0, v31, vcc
    s_mov_b64 exec, 1023
    global_load_dword v32, v[30:31], off
    s_mov_b64 exec, -1
Lpf_6:
    s_cmp_eq_u32 s45, 1
    s_cbranch_scc1 Lspec_3
    s_cmp_eq_u32 s45, 2
    s_cbranch_scc1 Lcomp_4
    s_cmp_ge_u32 s41, 2
    s_cbranch_scc1 Lcs_5
    s_setprio 0
    s_lshl_b32 s59, s42, 3
    s_and_b32 s47, s43, 7
    s_add_u32 s59, s59, s47
    s_lshr_b32 s60, s43, 3
    v_lshlrev_b32 v15, 4, v0
    s_lshl_b32 s60, s41, 20
    s_lshl_b32 s59, s59, 10
    s_add_u32 s59, s59, s60
    s_mul_i32 s60, s41, 16640
    s_waitcnt lgkmcnt(0)
    s_mov_b32 s8, s64
    s_mov_b32 s9, s65
    s_mov_b32 s10, 2097152
    s_mov_b32 s11, 0x00020000
    s_add_u32 m0, s60, 122976
    s_add_u32 s61, s59, 0
    buffer_load_dwordx4 v15, s[8:11], s61 offen lds
    s_add_u32 m0, s60, 124016
    s_add_u32 s61, s59, 65536
    buffer_load_dwordx4 v15, s[8:11], s61 offen lds
    s_add_u32 m0, s60, 125056
    s_add_u32 s61, s59, 131072
    buffer_load_dwordx4 v15, s[8:11], s61 offen lds
    s_add_u32 m0, s60, 126096
    s_add_u32 s61, s59, 196608
    buffer_load_dwordx4 v15, s[8:11], s61 offen lds
    s_add_u32 m0, s60, 127136
    s_add_u32 s61, s59, 262144
    buffer_load_dwordx4 v15, s[8:11], s61 offen lds
    s_add_u32 m0, s60, 128176
    s_add_u32 s61, s59, 327680
    buffer_load_dwordx4 v15, s[8:11], s61 offen lds
    s_add_u32 m0, s60, 129216
    s_add_u32 s61, s59, 393216
    buffer_load_dwordx4 v15, s[8:11], s61 offen lds
    s_add_u32 m0, s60, 130256
    s_add_u32 s61, s59, 458752
    buffer_load_dwordx4 v15, s[8:11], s61 offen lds
    s_add_u32 m0, s60, 131296
    s_add_u32 s61, s59, 524288
    buffer_load_dwordx4 v15, s[8:11], s61 offen lds
    s_add_u32 m0, s60, 132336
    s_add_u32 s61, s59, 589824
    buffer_load_dwordx4 v15, s[8:11], s61 offen lds
    s_add_u32 m0, s60, 133376
    s_add_u32 s61, s59, 655360
    buffer_load_dwordx4 v15, s[8:11], s61 offen lds
    s_add_u32 m0, s60, 134416
    s_add_u32 s61, s59, 720896
    buffer_load_dwordx4 v15, s[8:11], s61 offen lds
    s_add_u32 m0, s60, 135456
    s_add_u32 s61, s59, 786432
    buffer_load_dwordx4 v15, s[8:11], s61 offen lds
    s_add_u32 m0, s60, 136496
    s_add_u32 s61, s59, 851968
    buffer_load_dwordx4 v15, s[8:11], s61 offen lds
    s_add_u32 m0, s60, 137536
    s_add_u32 s61, s59, 917504
    buffer_load_dwordx4 v15, s[8:11], s61 offen lds
    s_add_u32 m0, s60, 138576
    s_add_u32 s61, s59, 983040
    buffer_load_dwordx4 v15, s[8:11], s61 offen lds
    s_lshl_b32 s47, s41, 2
    s_add_u32 s47, s47, 156256
    v_mov_b32 v7, s47
    v_and_b32 v10, 3, v0
    v_lshlrev_b32 v8, 2, v10
    v_add_u32 v8, 156288, v8
    s_or_b32 s47, s2, 60
    s_cmp_eq_u32 s47, 0xff
    s_cbranch_scc1 Llskip_7
    s_lshr_b32 s50, s42, 2
    s_lshl_b32 s50, s50, 3
    s_and_b32 s47, s43, 7
    s_add_u32 s50, s50, s47
    s_and_b32 s51, s42, 3
    s_lshl_b32 s51, s51, 2
    s_lshr_b32 s47, s43, 3
    s_add_u32 s51, s51, s47
    v_lshrrev_b32 v10, 3, v0
    v_lshlrev_b32 v10, 16, v10
    v_and_b32 v11, 7, v0
    v_lshrrev_b32 v12, 4, v0
    v_xor_b32 v11, v11, v12
    v_lshl_add_u32 v2, v11, 4, v10
    s_lshl_b32 s47, s50, 1
    s_add_u32 s47, s47, s41
    s_lshl_b32 s47, s47, 11
    v_add_u32 v2, s47, v2
    v_xor_b32 v3, 64, v2
    s_cmp_eq_u32 s51, 14
    s_cselect_b32 s58, 4, 64
    v_mov_b32 v14, 0x7f000000
    s_mov_b32 s48, 0x15555556
    s_movk_i32 s49, 2752
    s_mul_i32 s47, s51, 192
    s_mul_i32 s57, s41, 88064
    s_add_u32 s47, s47, s57
    v_add_u32 v10, 0, v0
    v_mul_hi_u32 v11, v10, s48
    v_mul_u32_u24 v12, 12, v11
    v_sub_u32 v12, v10, v12
    v_mul_lo_u32 v11, v11, s49
    v_lshl_add_u32 v4, v12, 4, v11
    v_add_u32 v4, s47, v4
    v_cmp_le_u32 vcc, s58, v12
    s_nop 1
    v_cndmask_b32 v4, v4, v14, vcc
    v_add_u32 v10, 64, v0
    v_mul_hi_u32 v11, v10, s48
    v_mul_u32_u24 v12, 12, v11
    v_sub_u32 v12, v10, v12
    v_mul_lo_u32 v11, v11, s49
    v_lshl_add_u32 v5, v12, 4, v11
    v_add_u32 v5, s47, v5
    v_cmp_le_u32 vcc, s58, v12
    s_nop 1
    v_cndmask_b32 v5, v5, v14, vcc
    v_add_u32 v10, 128, v0
    v_mul_hi_u32 v11, v10, s48
    v_mul_u32_u24 v12, 12, v11
    v_sub_u32 v12, v10, v12
    v_mul_lo_u32 v11, v11, s49
    v_lshl_add_u32 v6, v12, 4, v11
    v_add_u32 v6, s47, v6
    v_cmp_le_u32 vcc, s58, v12
    s_nop 1
    v_cndmask_b32 v6, v6, v14, vcc
    s_mov_b32 s52, 0
    s_mov_b32 s53, 0
    s_mov_b32 s54, 0
    v_and_b32 v13, 3, v0
    v_lshlrev_b32 v13, 2, v13
    v_add_u32 v13, 156464, v13
    s_waitcnt lgkmcnt(0)
    s_mov_b32 s8, s64
    s_mov_b32 s9, s65
    s_mov_b32 s10, 2097152
    s_mov_b32 s11, 0x00020000
    s_mov_b32 s12, s72
    s_mov_b32 s13, s73
    s_mov_b32 s14, 1409024
    s_mov_b32 s15, 0x00020000
    s_mov_b32 s16, s74
    s_mov_b32 s17, s75
    s_mov_b32 s18, 1409024
    s_mov_b32 s19, 0x00020000
    s_lshl_b32 s55, s52, 7
    s_mul_i32 s56, s52, 176128
    s_lshl_b32 s48, s41, 13
    s_add_u32 s48, s48, s54
    s_mul_i32 s49, s41, 6144
    s_add_u32 s49, s49, s54
    s_add_u32 m0, s48, 12288
    s_add_u32 s57, s55, 0
    buffer_load_dwordx4 v2, s[8:11], s57 offen lds
    s_add_u32 m0, s48, 13312
    s_add_u32 s57, s55, 524288
    buffer_load_dwordx4 v3, s[8:11], s57 offen lds
    s_add_u32 m0, s48, 14336
    s_add_u32 s57, s55, 1048576
    buffer_load_dwordx4 v2, s[8:11], s57 offen lds
    s_add_u32 m0, s48, 15360
    s_add_u32 s57, s55, 1572864
    buffer_load_dwordx4 v3, s[8:11], s57 offen lds
    s_add_u32 m0, s48, 16384
    s_add_u32 s57, s55, 1024
    buffer_load_dwordx4 v2, s[8:11], s57 offen lds
    s_add_u32 m0, s48, 17408
    s_add_u32 s57, s55, 525312
    buffer_load_dwordx4 v3, s[8:11], s57 offen lds
    s_add_u32 m0, s48, 18432
    s_add_u32 s57, s55, 1049600
    buffer_load_dwordx4 v2, s[8:11], s57 offen lds
    s_add_u32 m0, s48, 19456
    s_add_u32 s57, s55, 1573888
    buffer_load_dwordx4 v3, s[8:11], s57 offen lds
    s_add_u32 m0, s49, 0
    s_add_u32 s57, s56, 0
    buffer_load_dwordx4 v4, s[12:15], s57 offen lds
    s_add_u32 m0, s49, 1024
    s_add_u32 s57, s56, 0
    buffer_load_dwordx4 v5, s[12:15], s57 offen lds
    s_lshl_b32 s47, s41, 3
    s_add_u32 s47, s47, 156320
    v_mov_b32 v15, s47
    v_mov_b32 v16, 1
    v_mov_b32 v17, 1
    s_waitcnt vmcnt(10)
    ds_write_b64 v15, v[16:17]
    s_add_u32 m0, s49, 2048
    s_add_u32 s57, s56, 0
    buffer_load_dwordx4 v6, s[12:15], s57 offen lds
    s_add_u32 m0, s49, 3072
    s_add_u32 s57, s56, 44032
    buffer_load_dwordx4 v4, s[12:15], s57 offen lds
    s_add_u32 m0, s49, 4096
    s_add_u32 s57, s56, 44032
    buffer_load_dwordx4 v5, s[12:15], s57 offen lds
    s_add_u32 m0, s49, 5120
    s_add_u32 s57, s56, 44032
    buffer_load_dwordx4 v6, s[12:15], s57 offen lds
    s_add_u32 m0, s49, 28704
    s_add_u32 s57, s56, 0
    buffer_load_dwordx4 v4, s[16:19], s57 offen lds
    s_add_u32 m0, s49, 29728
    s_add_u32 s57, s56, 0
    buffer_load_dwordx4 v5, s[16:19], s57 offen lds
    s_add_u32 m0, s49, 30752
    s_add_u32 s57, s56, 0
    buffer_load_dwordx4 v6, s[16:19], s57 offen lds
    s_add_u32 m0, s49, 31776
    s_add_u32 s57, s56, 44032
    buffer_load_dwordx4 v4, s[16:19], s57 offen lds
    s_add_u32 m0, s49, 32800
    s_add_u32 s57, s56, 44032
    buffer_load_dwordx4 v5, s[16:19], s57 offen lds
    s_add_u32 m0, s49, 33824
    s_add_u32 s57, s56, 44032
    buffer_load_dwordx4 v6, s[16:19], s57 offen lds
    s_add_u32 s52, s52, 1
    s_and_b32 s52, s52, 7
    s_add_u32 s54, s54, 40992
    s_cmp_eq_u32 s54, 122976
    s_cselect_b32 s54, 0, s54
    s_add_u32 s53, s53, 1
Lld_8:
    s_cmp_lt_u32 s53, 3
    s_cbranch_scc1 Lnf_9
    s_sub_u32 s47, s53, 2
    ds_read_b32 v9, v8
    s_waitcnt lgkmcnt(0)
    v_cmp_gt_u32 vcc, s47, v9
    s_cbranch_vccnz Lst_12
Lrt_13:
Lnf_9:
    s_lshl_b32 s55, s52, 7
    s_mul_i32 s56, s52, 176128
    s_lshl_b32 s48, s41, 13
    s_add_u32 s48, s48, s54
    s_mul_i32 s49, s41, 6144
    s_add_u32 s49, s49, s54
    s_add_u32 m0, s48, 12288
    s_add_u32 s57, s55, 0
    buffer_load_dwordx4 v2, s[8:11], s57 offen lds
    s_add_u32 m0, s48, 13312
    s_add_u32 s57, s55, 524288
    buffer_load_dwordx4 v3, s[8:11], s57 offen lds
    s_add_u32 m0, s48, 14336
    s_add_u32 s57, s55, 1048576
    buffer_load_dwordx4 v2, s[8:11], s57 offen lds
    s_add_u32 m0, s48, 15360
    s_add_u32 s57, s55, 1572864
    buffer_load_dwordx4 v3, s[8:11], s57 offen lds
    s_add_u32 m0, s48, 16384
    s_add_u32 s57, s55, 1024
    buffer_load_dwordx4 v2, s[8:11], s57 offen lds
    s_add_u32 m0, s48, 17408
    s_add_u32 s57, s55, 525312
    buffer_load_dwordx4 v3, s[8:11], s57 offen lds
    s_add_u32 m0, s48, 18432
    s_add_u32 s57, s55, 1049600
    buffer_load_dwordx4 v2, s[8:11], s57 offen lds
    s_add_u32 m0, s48, 19456
    s_add_u32 s57, s55, 1573888
    buffer_load_dwordx4 v3, s[8:11], s57 offen lds
    s_add_u32 m0, s49, 0
    s_add_u32 s57, s56, 0
    buffer_load_dwordx4 v4, s[12:15], s57 offen lds
    s_add_u32 m0, s49, 1024
    s_add_u32 s57, s56, 0
    buffer_load_dwordx4 v5, s[12:15], s57 offen lds
    s_waitcnt vmcnt(10)
    v_mov_b32 v9, s53
    ds_write_b32 v7, v9
    s_add_u32 m0, s49, 2048
    s_add_u32 s57, s56, 0
    buffer_load_dwordx4 v6, s[12:15], s57 offen lds
    s_add_u32 m0, s49, 3072
    s_add_u32 s57, s56, 44032
    buffer_load_dwordx4 v4, s[12:15], s57 offen lds
    s_add_u32 m0, s49, 4096
    s_add_u32 s57, s56, 44032
    buffer_load_dwordx4 v5, s[12:15], s57 offen lds
    s_add_u32 m0, s49, 5120
    s_add_u32 s57, s56, 44032
    buffer_load_dwordx4 v6, s[12:15], s57 offen lds
    s_add_u32 m0, s49, 28704
    s_add_u32 s57, s56, 0
    buffer_load_dwordx4 v4, s[16:19], s57 offen lds
    s_add_u32 m0, s49, 29728
    s_add_u32 s57, s56, 0
    buffer_load_dwordx4 v5, s[16:19], s57 offen lds
    s_add_u32 m0, s49, 30752
    s_add_u32 s57, s56, 0
    buffer_load_dwordx4 v6, s[16:19], s57 offen lds
    s_add_u32 m0, s49, 31776
    s_add_u32 s57, s56, 44032
    buffer_load_dwordx4 v4, s[16:19], s57 offen lds
    s_add_u32 m0, s49, 32800
    s_add_u32 s57, s56, 44032
    buffer_load_dwordx4 v5, s[16:19], s57 offen lds
    s_add_u32 m0, s49, 33824
    s_add_u32 s57, s56, 44032
    buffer_load_dwordx4 v6, s[16:19], s57 offen lds
    s_add_u32 s52, s52, 1
    s_and_b32 s52, s52, 7
    s_add_u32 s54, s54, 40992
    s_cmp_eq_u32 s54, 122976
    s_cselect_b32 s54, 0, s54
    s_add_u32 s53, s53, 1
    s_cmp_lt_u32 s53, 8
    s_cbranch_scc1 Lld_8
Lljoin_15:
    s_and_b32 s47, s43, 3
    s_lshl2_add_u32 s50, s42, s47
    s_lshr_b32 s51, s43, 2
    s_mov_b32 s8, s76
    s_mov_b32 s9, s77
    s_mov_b32 s10, 1409024
    s_mov_b32 s11, 0x00020000
    v_lshrrev_b32 v10, 3, v0
    v_and_b32 v11, 7, v0
    v_and_b32 v12, 16, v0
    v_lshrrev_b32 v12, 2, v12
    v_xor_b32 v11, v11, v12
    v_lshlrev_b32 v10, 10, v10
    v_lshl_add_u32 v2, v11, 4, v10
    s_mul_i32 s47, s41, 49152
    s_lshl_b32 s48, s51, 7
    s_add_u32 s47, s47, s48
    v_add_u32 v2, s47, v2
    s_mul_i32 s49, s41, 10240
    s_and_b32 s52, s43, 3
    s_lshl_b32 s52, s52, 1
    s_xor_b32 s52, s52, s51
    s_lshl_b32 s52, s52, 1
    s_and_b32 s47, s42, 1
    s_add_u32 s52, s52, s47
    s_min_u32 s52, s52, 13
    s_mul_i32 s52, s52, 98304
    s_sub_u32 s53, s52, 1376256
    s_waitcnt vmcnt(0)
    v_mov_b32 v9, 8
    ds_write_b32 v7, v9
    ds_read_b32 v9, v8
    s_waitcnt lgkmcnt(0)
    v_cmp_gt_u32 vcc, 6, v9
    s_cbranch_vccnz Lst_16
Lrt_17:
    s_add_u32 m0, s49, 81984
    s_cmp_ge_u32 s52, 1376256
    s_cselect_b32 s57, s53, s52
    s_add_u32 s57, s57, 0
    buffer_load_dwordx4 v2, s[8:11], s57 offen lds
    s_add_u32 m0, s49, 83008
    s_add_u32 s57, s57, 8192
    buffer_load_dwordx4 v2, s[8:11], s57 offen lds
    s_add_u32 m0, s49, 84032
    s_cmp_ge_u32 s52, 1277952
    s_cselect_b32 s57, s53, s52
    s_add_u32 s57, s57, 98304
    buffer_load_dwordx4 v2, s[8:11], s57 offen lds
    s_add_u32 m0, s49, 85056
    s_add_u32 s57, s57, 8192
    buffer_load_dwordx4 v2, s[8:11], s57 offen lds
    s_add_u32 m0, s49, 86080
    s_cmp_ge_u32 s52, 1179648
    s_cselect_b32 s57, s53, s52
    s_add_u32 s57, s57, 196608
    buffer_load_dwordx4 v2, s[8:11], s57 offen lds
    s_add_u32 m0, s49, 87104
    s_add_u32 s57, s57, 8192
    buffer_load_dwordx4 v2, s[8:11], s57 offen lds
    s_add_u32 m0, s49, 88128
    s_cmp_ge_u32 s52, 1081344
    s_cselect_b32 s57, s53, s52
    s_add_u32 s57, s57, 294912
    buffer_load_dwordx4 v2, s[8:11], s57 offen lds
    s_add_u32 m0, s49, 89152
    s_add_u32 s57, s57, 8192
    buffer_load_dwordx4 v2, s[8:11], s57 offen lds
    s_add_u32 m0, s49, 90176
    s_cmp_ge_u32 s52, 983040
    s_cselect_b32 s57, s53, s52
    s_add_u32 s57, s57, 393216
    buffer_load_dwordx4 v2, s[8:11], s57 offen lds
    s_add_u32 m0, s49, 91200
    s_add_u32 s57, s57, 8192
    buffer_load_dwordx4 v2, s[8:11], s57 offen lds
    s_add_u32 m0, s49, 102464
    s_cmp_ge_u32 s52, 884736
    s_cselect_b32 s57, s53, s52
    s_add_u32 s57, s57, 491520
    buffer_load_dwordx4 v2, s[8:11], s57 offen lds
    s_add_u32 m0, s49, 103488
    s_add_u32 s57, s57, 8192
    buffer_load_dwordx4 v2, s[8:11], s57 offen lds
    s_add_u32 m0, s49, 104512
    s_cmp_ge_u32 s52, 786432
    s_cselect_b32 s57, s53, s52
    s_add_u32 s57, s57, 589824
    buffer_load_dwordx4 v2, s[8:11], s57 offen lds
    s_add_u32 m0, s49, 105536
    s_add_u32 s57, s57, 8192
    buffer_load_dwordx4 v2, s[8:11], s57 offen lds
    s_add_u32 m0, s49, 106560
    s_cmp_ge_u32 s52, 688128
    s_cselect_b32 s57, s53, s52
    s_add_u32 s57, s57, 688128
    buffer_load_dwordx4 v2, s[8:11], s57 offen lds
    s_add_u32 m0, s49, 107584
    s_add_u32 s57, s57, 8192
    buffer_load_dwordx4 v2, s[8:11], s57 offen lds
    s_add_u32 m0, s49, 108608
    s_cmp_ge_u32 s52, 589824
    s_cselect_b32 s57, s53, s52
    s_add_u32 s57, s57, 786432
    buffer_load_dwordx4 v2, s[8:11], s57 offen lds
    s_add_u32 m0, s49, 109632
    s_add_u32 s57, s57, 8192
    buffer_load_dwordx4 v2, s[8:11], s57 offen lds
    s_add_u32 m0, s49, 110656
    s_cmp_ge_u32 s52, 491520
    s_cselect_b32 s57, s53, s52
    s_add_u32 s57, s57, 884736
    buffer_load_dwordx4 v2, s[8:11], s57 offen lds
    s_add_u32 m0, s49, 111680
    s_add_u32 s57, s57, 8192
    buffer_load_dwordx4 v2, s[8:11], s57 offen lds
    ds_read_b32 v9, v8
    s_waitcnt lgkmcnt(0)
    v_cmp_gt_u32 vcc, 7, v9
    s_cbranch_vccnz Lst_19
Lrt_20:
    s_add_u32 m0, s49, 0
    s_cmp_ge_u32 s52, 393216
    s_cselect_b32 s57, s53, s52
    s_add_u32 s57, s57, 983040
    buffer_load_dwordx4 v2, s[8:11], s57 offen lds
    s_add_u32 m0, s49, 1024
    s_add_u32 s57, s57, 8192
    buffer_load_dwordx4 v2, s[8:11], s57 offen lds
    s_add_u32 m0, s49, 2048
    s_cmp_ge_u32 s52, 294912
    s_cselect_b32 s57, s53, s52
    s_add_u32 s57, s57, 1081344
    buffer_load_dwordx4 v2, s[8:11], s57 offen lds
    s_add_u32 m0, s49, 3072
    s_add_u32 s57, s57, 8192
    buffer_load_dwordx4 v2, s[8:11], s57 offen lds
    s_add_u32 m0, s49, 4096
    s_cmp_ge_u32 s52, 196608
    s_cselect_b32 s57, s53, s52
    s_add_u32 s57, s57, 1179648
    buffer_load_dwordx4 v2, s[8:11], s57 offen lds
    s_add_u32 m0, s49, 5120
    s_add_u32 s57, s57, 8192
    buffer_load_dwordx4 v2, s[8:11], s57 offen lds
    s_add_u32 m0, s49, 6144
    s_cmp_ge_u32 s52, 98304
    s_cselect_b32 s57, s53, s52
    s_add_u32 s57, s57, 1277952
    buffer_load_dwordx4 v2, s[8:11], s57 offen lds
    s_add_u32 m0, s49, 7168
    s_add_u32 s57, s57, 8192
    buffer_load_dwordx4 v2, s[8:11], s57 offen lds
    s_add_u32 m0, s49, 8192
    s_mov_b32 s57, 1376256
    buffer_load_dwordx4 v2, s[8:11], s57 offen lds
    s_add_u32 m0, s49, 9216
    s_mov_b32 s57, 1384448
    buffer_load_dwordx4 v2, s[8:11], s57 offen lds
    s_add_u32 m0, s49, 20480
    s_cmp_ge_u32 s52, 1376256
    s_cselect_b32 s57, s53, s52
    s_add_u32 s57, s57, 16384
    buffer_load_dwordx4 v2, s[8:11], s57 offen lds
    s_add_u32 m0, s49, 21504
    s_add_u32 s57, s57, 8192
    buffer_load_dwordx4 v2, s[8:11], s57 offen lds
    s_add_u32 m0, s49, 22528
    s_cmp_ge_u32 s52, 1277952
    s_cselect_b32 s57, s53, s52
    s_add_u32 s57, s57, 114688
    buffer_load_dwordx4 v2, s[8:11], s57 offen lds
    s_add_u32 m0, s49, 23552
    s_add_u32 s57, s57, 8192
    buffer_load_dwordx4 v2, s[8:11], s57 offen lds
    s_add_u32 m0, s49, 24576
    s_cmp_ge_u32 s52, 1179648
    s_cselect_b32 s57, s53, s52
    s_add_u32 s57, s57, 212992
    buffer_load_dwordx4 v2, s[8:11], s57 offen lds
    s_add_u32 m0, s49, 25600
    s_add_u32 s57, s57, 8192
    buffer_load_dwordx4 v2, s[8:11], s57 offen lds
    s_add_u32 m0, s49, 26624
    s_cmp_ge_u32 s52, 1081344
    s_cselect_b32 s57, s53, s52
    s_add_u32 s57, s57, 311296
    buffer_load_dwordx4 v2, s[8:11], s57 offen lds
    s_add_u32 m0, s49, 27648
    s_add_u32 s57, s57, 8192
    buffer_load_dwordx4 v2, s[8:11], s57 offen lds
    s_add_u32 m0, s49, 28672
    s_cmp_ge_u32 s52, 983040
    s_cselect_b32 s57, s53, s52
    s_add_u32 s57, s57, 409600
    buffer_load_dwordx4 v2, s[8:11], s57 offen lds
    s_add_u32 m0, s49, 29696
    s_add_u32 s57, s57, 8192
    buffer_load_dwordx4 v2, s[8:11], s57 offen lds
    s_waitcnt vmcnt(30)
    v_mov_b32 v9, 9
    ds_write_b32 v7, v9
    s_waitcnt vmcnt(20)
    v_mov_b32 v9, 10
    ds_write_b32 v7, v9
    ds_read_b32 v9, v8
    s_waitcnt lgkmcnt(0)
    v_cmp_gt_u32 vcc, 8, v9
    s_cbranch_vccnz Lst_22
Lrt_23:
    s_add_u32 m0, s49, 40992
    s_cmp_ge_u32 s52, 884736
    s_cselect_b32 s57, s53, s52
    s_add_u32 s57, s57, 507904
    buffer_load_dwordx4 v2, s[8:11], s57 offen lds
    s_add_u32 m0, s49, 42016
    s_add_u32 s57, s57, 8192
    buffer_load_dwordx4 v2, s[8:11], s57 offen lds
    s_add_u32 m0, s49, 43040
    s_cmp_ge_u32 s52, 786432
    s_cselect_b32 s57, s53, s52
    s_add_u32 s57, s57, 606208
    buffer_load_dwordx4 v2, s[8:11], s57 offen lds
    s_add_u32 m0, s49, 44064
    s_add_u32 s57, s57, 8192
    buffer_load_dwordx4 v2, s[8:11], s57 offen lds
    s_add_u32 m0, s49, 45088
    s_cmp_ge_u32 s52, 688128
    s_cselect_b32 s57, s53, s52
    s_add_u32 s57, s57, 704512
    buffer_load_dwordx4 v2, s[8:11], s57 offen lds
    s_add_u32 m0, s49, 46112
    s_add_u32 s57, s57, 8192
    buffer_load_dwordx4 v2, s[8:11], s57 offen lds
    s_add_u32 m0, s49, 47136
    s_cmp_ge_u32 s52, 589824
    s_cselect_b32 s57, s53, s52
    s_add_u32 s57, s57, 802816
    buffer_load_dwordx4 v2, s[8:11], s57 offen lds
    s_add_u32 m0, s49, 48160
    s_add_u32 s57, s57, 8192
    buffer_load_dwordx4 v2, s[8:11], s57 offen lds
    s_add_u32 m0, s49, 49184
    s_cmp_ge_u32 s52, 491520
    s_cselect_b32 s57, s53, s52
    s_add_u32 s57, s57, 901120
    buffer_load_dwordx4 v2, s[8:11], s57 offen lds
    s_add_u32 m0, s49, 50208
    s_add_u32 s57, s57, 8192
    buffer_load_dwordx4 v2, s[8:11], s57 offen lds
    s_add_u32 m0, s49, 61472
    s_cmp_ge_u32 s52, 393216
    s_cselect_b32 s57, s53, s52
    s_add_u32 s57, s57, 999424
    buffer_load_dwordx4 v2, s[8:11], s57 offen lds
    s_add_u32 m0, s49, 62496
    s_add_u32 s57, s57, 8192
    buffer_load_dwordx4 v2, s[8:11], s57 offen lds
    s_add_u32 m0, s49, 63520
    s_cmp_ge_u32 s52, 294912
    s_cselect_b32 s57, s53, s52
    s_add_u32 s57, s57, 1097728
    buffer_load_dwordx4 v2, s[8:11], s57 offen lds
    s_add_u32 m0, s49, 64544
    s_add_u32 s57, s57, 8192
    buffer_load_dwordx4 v2, s[8:11], s57 offen lds
    s_add_u32 m0, s49, 65568
    s_cmp_ge_u32 s52, 196608
    s_cselect_b32 s57, s53, s52
    s_add_u32 s57, s57, 1196032
    buffer_load_dwordx4 v2, s[8:11], s57 offen lds
    s_add_u32 m0, s49, 66592
    s_add_u32 s57, s57, 8192
    buffer_load_dwordx4 v2, s[8:11], s57 offen lds
    s_add_u32 m0, s49, 67616
    s_cmp_ge_u32 s52, 98304
    s_cselect_b32 s57, s53, s52
    s_add_u32 s57, s57, 1294336
    buffer_load_dwordx4 v2, s[8:11], s57 offen lds
    s_add_u32 m0, s49, 68640
    s_add_u32 s57, s57, 8192
    buffer_load_dwordx4 v2, s[8:11], s57 offen lds
    s_add_u32 m0, s49, 69664
    s_mov_b32 s57, 1392640
    buffer_load_dwordx4 v2, s[8:11], s57 offen lds
    s_add_u32 m0, s49, 70688
    s_mov_b32 s57, 1400832
    buffer_load_dwordx4 v2, s[8:11], s57 offen lds
    s_waitcnt vmcnt(30)
    v_mov_b32 v9, 11
    ds_write_b32 v7, v9
    s_waitcnt vmcnt(20)
    v_mov_b32 v9, 12
    ds_write_b32 v7, v9
    s_waitcnt vmcnt(10)
    v_mov_b32 v9, 13
    ds_write_b32 v7, v9
    s_waitcnt vmcnt(0)
    v_mov_b32 v9, 14
    ds_write_b32 v7, v9
    ds_read_b32 v9, v8
    s_waitcnt lgkmcnt(0)
    v_cmp_gt_u32 vcc, 9, v9
    s_cbranch_vccnz Lst_25
Lrt_26:
    s_add_u32 m0, s49, 81984
    s_cmp_ge_u32 s52, 1376256
    s_cselect_b32 s57, s53, s52
    s_add_u32 s57, s57, 32768
    buffer_load_dwordx4 v2, s[8:11], s57 offen lds
    s_add_u32 m0, s49, 83008
    s_add_u32 s57, s57, 8192
    buffer_load_dwordx4 v2, s[8:11], s57 offen lds
    s_add_u32 m0, s49, 84032
    s_cmp_ge_u32 s52, 1277952
    s_cselect_b32 s57, s53, s52
    s_add_u32 s57, s57, 131072
    buffer_load_dwordx4 v2, s[8:11], s57 offen lds
    s_add_u32 m0, s49, 85056
    s_add_u32 s57, s57, 8192
    buffer_load_dwordx4 v2, s[8:11], s57 offen lds
    s_add_u32 m0, s49, 86080
    s_cmp_ge_u32 s52, 1179648
    s_cselect_b32 s57, s53, s52
    s_add_u32 s57, s57, 229376
    buffer_load_dwordx4 v2, s[8:11], s57 offen lds
    s_add_u32 m0, s49, 87104
    s_add_u32 s57, s57, 8192
    buffer_load_dwordx4 v2, s[8:11], s57 offen lds
    s_add_u32 m0, s49, 88128
    s_cmp_ge_u32 s52, 1081344
    s_cselect_b32 s57, s53, s52
    s_add_u32 s57, s57, 327680
    buffer_load_dwordx4 v2, s[8:11], s57 offen lds
    s_add_u32 m0, s49, 89152
    s_add_u32 s57, s57, 8192
    buffer_load_dwordx4 v2, s[8:11], s57 offen lds
    s_add_u32 m0, s49, 90176
    s_cmp_ge_u32 s52, 983040
    s_cselect_b32 s57, s53, s52
    s_add_u32 s57, s57, 425984
    buffer_load_dwordx4 v2, s[8:11], s57 offen lds
    s_add_u32 m0, s49, 91200
    s_add_u32 s57, s57, 8192
    buffer_load_dwordx4 v2, s[8:11], s57 offen lds
    ds_read_b32 v9, v8
    s_waitcnt lgkmcnt(0)
    v_cmp_gt_u32 vcc, 10, v9
    s_cbranch_vccnz Lst_28
Lrt_29:
    s_add_u32 m0, s49, 102464
    s_cmp_ge_u32 s52, 884736
    s_cselect_b32 s57, s53, s52
    s_add_u32 s57, s57, 524288
    buffer_load_dwordx4 v2, s[8:11], s57 offen lds
    s_add_u32 m0, s49, 103488
    s_add_u32 s57, s57, 8192
    buffer_load_dwordx4 v2, s[8:11], s57 offen lds
    s_add_u32 m0, s49, 104512
    s_cmp_ge_u32 s52, 786432
    s_cselect_b32 s57, s53, s52
    s_add_u32 s57, s57, 622592
    buffer_load_dwordx4 v2, s[8:11], s57 offen lds
    s_add_u32 m0, s49, 105536
    s_add_u32 s57, s57, 8192
    buffer_load_dwordx4 v2, s[8:11], s57 offen lds
    s_add_u32 m0, s49, 106560
    s_cmp_ge_u32 s52, 688128
    s_cselect_b32 s57, s53, s52
    s_add_u32 s57, s57, 720896
    buffer_load_dwordx4 v2, s[8:11], s57 offen lds
    s_add_u32 m0, s49, 107584
    s_add_u32 s57, s57, 8192
    buffer_load_dwordx4 v2, s[8:11], s57 offen lds
    s_add_u32 m0, s49, 108608
    s_cmp_ge_u32 s52, 589824
    s_cselect_b32 s57, s53, s52
    s_add_u32 s57, s57, 819200
    buffer_load_dwordx4 v2, s[8:11], s57 offen lds
    s_add_u32 m0, s49, 109632
    s_add_u32 s57, s57, 8192
    buffer_load_dwordx4 v2, s[8:11], s57 offen lds
    s_add_u32 m0, s49, 110656
    s_cmp_ge_u32 s52, 491520
    s_cselect_b32 s57, s53, s52
    s_add_u32 s57, s57, 917504
    buffer_load_dwordx4 v2, s[8:11], s57 offen lds
    s_add_u32 m0, s49, 111680
    s_add_u32 s57, s57, 8192
    buffer_load_dwordx4 v2, s[8:11], s57 offen lds
    ds_read_b32 v9, v8
    s_waitcnt lgkmcnt(0)
    v_cmp_gt_u32 vcc, 11, v9
    s_cbranch_vccnz Lst_31
Lrt_32:
    s_add_u32 m0, s49, 0
    s_cmp_ge_u32 s52, 393216
    s_cselect_b32 s57, s53, s52
    s_add_u32 s57, s57, 1015808
    buffer_load_dwordx4 v2, s[8:11], s57 offen lds
    s_add_u32 m0, s49, 1024
    s_add_u32 s57, s57, 8192
    buffer_load_dwordx4 v2, s[8:11], s57 offen lds
    s_add_u32 m0, s49, 2048
    s_cmp_ge_u32 s52, 294912
    s_cselect_b32 s57, s53, s52
    s_add_u32 s57, s57, 1114112
    buffer_load_dwordx4 v2, s[8:11], s57 offen lds
    s_add_u32 m0, s49, 3072
    s_add_u32 s57, s57, 8192
    buffer_load_dwordx4 v2, s[8:11], s57 offen lds
    s_add_u32 m0, s49, 4096
    s_cmp_ge_u32 s52, 196608
    s_cselect_b32 s57, s53, s52
    s_add_u32 s57, s57, 1212416
    buffer_load_dwordx4 v2, s[8:11], s57 offen lds
    s_add_u32 m0, s49, 5120
    s_add_u32 s57, s57, 8192
    buffer_load_dwordx4 v2, s[8:11], s57 offen lds
    s_add_u32 m0, s49, 6144
    s_cmp_ge_u32 s52, 98304
    s_cselect_b32 s57, s53, s52
    s_add_u32 s57, s57, 1310720
    buffer_load_dwordx4 v2, s[8:11], s57 offen lds
    s_add_u32 m0, s49, 7168
    s_add_u32 s57, s57, 8192
    buffer_load_dwordx4 v2, s[8:11], s57 offen lds
    s_waitcnt vmcnt(18)
    v_mov_b32 v9, 15
    ds_write_b32 v7, v9
    s_waitcnt vmcnt(8)
    v_mov_b32 v9, 16
    ds_write_b32 v7, v9
    s_waitcnt vmcnt(0)
    v_mov_b32 v9, 17
    ds_write_b32 v7, v9
    s_endpgm
Lst_12:
    s_mov_b32 s46, 200000
    v_mov_b32 v9, s53
    s_waitcnt vmcnt(0)
    ds_write_b32 v7, v9
Llp_14:
    s_sleep 1
    ds_read_b32 v9, v8
    s_waitcnt lgkmcnt(0)
    v_cmp_gt_u32 vcc, s47, v9
    s_cbranch_vccz Lrt_13
    s_sub_u32 s46, s46, 1
    s_cbranch_scc0 Llp_14
    s_branch Lrt_13
Lst_16:
    s_mov_b32 s46, 200000
Llp_18:
    s_sleep 1
    ds_read_b32 v9, v8
    s_waitcnt lgkmcnt(0)
    v_cmp_gt_u32 vcc, 6, v9
    s_cbranch_vccz Lrt_17
    s_sub_u32 s46, s46, 1
    s_cbranch_scc0 Llp_18
    s_branch Lrt_17
Lst_19:
    s_mov_b32 s46, 200000
Llp_21:
    s_sleep 1
    ds_read_b32 v9, v8
    s_waitcnt lgkmcnt(0)
    v_cmp_gt_u32 vcc, 7, v9
    s_cbranch_vccz Lrt_20
    s_sub_u32 s46, s46, 1
    s_cbranch_scc0 Llp_21
    s_branch Lrt_20
Lst_22:
    s_mov_b32 s46, 200000
Llp_24:
    s_sleep 1
    ds_read_b32 v9, v8
    s_waitcnt lgkmcnt(0)
    v_cmp_gt_u32 vcc, 8, v9
    s_cbranch_vccz Lrt_23
    s_sub_u32 s46, s46, 1
    s_cbranch_scc0 Llp_24
    s_branch Lrt_23
Lst_25:
    s_mov_b32 s46, 200000
Llp_27:
    s_sleep 1
    ds_read_b32 v9, v8
    s_waitcnt lgkmcnt(0)
    v_cmp_gt_u32 vcc, 9, v9
    s_cbranch_vccz Lrt_26
    s_sub_u32 s46, s46, 1
    s_cbranch_scc0 Llp_27
    s_branch Lrt_26
Lst_28:
    s_mov_b32 s46, 200000
Llp_30:
    s_sleep 1
    ds_read_b32 v9, v8
    s_waitcnt lgkmcnt(0)
    v_cmp_gt_u32 vcc, 10, v9
    s_cbranch_vccz Lrt_29
    s_sub_u32 s46, s46, 1
    s_cbranch_scc0 Llp_30
    s_branch Lrt_29
Lst_31:
    s_mov_b32 s46, 200000
Llp_33:
    s_sleep 1
    ds_read_b32 v9, v8
    s_waitcnt lgkmcnt(0)
    v_cmp_gt_u32 vcc, 11, v9
    s_cbranch_vccz Lrt_32
    s_sub_u32 s46, s46, 1
    s_cbranch_scc0 Llp_33
    s_branch Lrt_32
Llskip_7:
    s_lshl_b32 s47, s41, 3
    s_add_u32 s47, s47, 156320
    v_mov_b32 v15, s47
    v_mov_b32 v16, 1
    v_mov_b32 v17, 1
    s_waitcnt vmcnt(0)
    ds_write_b64 v15, v[16:17]
    s_cmp_lg_u32 s2, 0xff
    s_cbranch_scc1 Lljoin_15
    v_and_b32 v13, 3, v0
    v_lshlrev_b32 v13, 2, v13
    v_add_u32 v13, 156432, v13
    ds_read_b32 v9, v13
    s_waitcnt lgkmcnt(0)
    v_cmp_gt_u32 vcc, 2, v9
    s_cbranch_vccnz Lst_34
Lrt_35:
    s_branch Lljoin_15
    s_endpgm
Lst_34:
    s_mov_b32 s46, 200000
Llp_36:
    s_sleep 4
    ds_read_b32 v9, v13
    s_waitcnt lgkmcnt(0)
    v_cmp_gt_u32 vcc, 2, v9
    s_cbranch_vccz Lrt_35
    s_sub_u32 s46, s46, 1
    s_cbranch_scc0 Llp_36
    s_branch Lrt_35
Lcs_5:
    s_setprio 3
    s_cmp_eq_u32 s41, 3
    s_cbranch_scc1 Lpb_37
    s_waitcnt lgkmcnt(0)
    s_add_u32 s48, s82, 14942208
    s_addc_u32 s49, s83, 0
    s_load_dword s44, s[48:49], 0
    v_and_b32 v2, 3, v0
    v_lshlrev_b32 v2, 2, v2
    v_add_u32 v2, 156432, v2
    v_mov_b32 v5, 156256
    v_mov_b32 v6, 1
    s_lshl_b32 s50, s42, 3
    s_and_b32 s47, s43, 7
    s_add_u32 s50, s50, s47
    s_lshr_b32 s51, s43, 3
    s_lshl_b32 s52, s2, 8
    s_add_u32 s54, s52, 14680064
    s_add_u32 s54, s82, s54
    s_addc_u32 s55, s83, 0
    s_lshr_b32 s52, s50, 4
    s_lshl_b32 s52, s52, 2
    s_add_u32 s52, s52, s51
    s_lshl_b32 s52, s52, 4
    s_and_b32 s53, s50, 15
    s_add_u32 s52, s52, s53
    s_lshl_b32 s52, s52, 9
    s_add_u32 s56, s52, 14811136
    s_add_u32 s56, s82, s56
    s_addc_u32 s57, s83, 0
    s_mul_i32 s52, s50, 1536
    s_add_u32 s58, s52, 15073280
    s_add_u32 s58, s82, s58
    s_addc_u32 s59, s83, 0
    s_waitcnt lgkmcnt(0)
    s_mul_i32 s44, s44, 0x9E3779B1
    s_add_u32 s44, s44, 0x7F4A7C15
    s_mov_b32 s8, s44
    s_mov_b32 s9, s44
    s_mov_b32 s10, s44
    s_mov_b32 s11, s44
    s_mov_b32 s12, s44
    s_mov_b32 s13, s44
    s_mov_b32 s14, s44
    s_mov_b32 s15, s44
    s_mov_b32 s16, s44
    s_mov_b32 s17, s44
    s_mov_b32 s18, s44
    s_atomic_swap s8, s[54:55], 0 glc
    s_atomic_swap s9, s[56:57], 0 glc
    s_atomic_swap s10, s[56:57], 256 glc
    s_cmp_lg_u32 s51, 0
    s_cbranch_scc1 Ln3_38
    s_atomic_swap s11, s[58:59], 0 glc
    s_atomic_swap s12, s[58:59], 256 glc
    s_atomic_swap s13, s[58:59], 512 glc
    s_atomic_swap s14, s[58:59], 768 glc
    s_atomic_swap s15, s[58:59], 1024 glc
    s_atomic_swap s16, s[58:59], 1280 glc
Ln3_38:
    s_cmp_ge_u32 s2, 96
    s_cbranch_scc1 Lns_39
    s_atomic_swap s17, s[54:55], 65536 glc
Lns_39:
    v_mov_b32 v7, s44
    s_xor_b32 s52, s2, 0xff
    s_lshr_b32 s53, s52, 4
    s_lshl_b32 s53, s53, 4
    s_and_b32 s52, s52, 3
    s_add_u32 s52, s52, s53
    s_lshl_b32 s52, s52, 8
    s_add_u32 s60, s52, 14680064
    s_add_u32 s60, s82, s60
    s_addc_u32 s61, s83, 0
    s_and_b32 s47, s43, 3
    s_lshl2_add_u32 s50, s42, s47
    s_lshr_b32 s51, s43, 2
    s_lshr_b32 s52, s50, 3
    s_lshl_b32 s52, s52, 7
    s_and_b32 s53, s43, 15
    s_add_u32 s52, s52, s53
    s_lshl_b32 s52, s52, 8
    s_add_u32 s62, s52, 14811136
    s_add_u32 s62, s82, s62
    s_addc_u32 s63, s83, 0
    s_waitcnt lgkmcnt(0)
    ds_write_b32 v5, v7 offset:128
    ds_write_b32 v5, v6 offset:84
    v_and_b32 v20, 3, v0
    v_lshlrev_b32 v20, 2, v20
    v_add_u32 v20, 156320, v20
    ds_read_b32 v8, v20
    s_waitcnt lgkmcnt(0)
    v_cmp_gt_u32 vcc, 1, v8
    s_cbranch_vccnz Lst_40
Lrt_41:
    v_min_u32 v20, 42, v0
    v_lshlrev_b32 v20, 7, v20
    s_mul_i32 s47, s2, 5504
    s_mov_b32 s20, s76
    s_mov_b32 s21, s77
    s_mov_b32 s22, 1409024
    s_mov_b32 s23, 0x00020000
    buffer_load_dword v23, v20, s[20:23], s47 offen
    ds_read_b32 v8, v2
    s_waitcnt lgkmcnt(0)
    v_cmp_gt_u32 vcc, 1, v8
    s_cbranch_vccnz Lst_43
Lrt_44:
    s_add_u32 s47, s44, 16
    s_mov_b32 s46, 60000
Lgl_46:
    s_mov_b32 s8, 0
    s_mov_b32 s9, 0
    s_mov_b32 s10, 0
    s_mov_b32 s11, 0
    s_atomic_or s8, s[60:61], 0 glc
    s_atomic_or s9, s[60:61], 1024 glc
    s_atomic_or s10, s[60:61], 2048 glc
    s_atomic_or s11, s[60:61], 3072 glc
    s_waitcnt lgkmcnt(0)
    s_xor_b32 s8, s8, s47
    s_xor_b32 s9, s9, s47
    s_xor_b32 s10, s10, s47
    s_xor_b32 s11, s11, s47
    s_or_b32 s8, s8, s9
    s_or_b32 s8, s8, s10
    s_or_b32 s8, s8, s11
    s_cbranch_scc0 Lgd_47
    s_sleep 4
    s_sub_u32 s46, s46, 1
    s_cbranch_scc0 Lgl_46
Lgd_47:
    ds_write_b32 v5, v6 offset:88
    ds_read_b32 v8, v2
    s_waitcnt lgkmcnt(0)
    v_cmp_gt_u32 vcc, 2, v8
    s_cbranch_vccnz Lst_48
Lrt_49:
    s_add_u32 s47, s44, 32
    s_mov_b32 s46, 60000
Lgl_51:
    s_mov_b32 s8, 0
    s_mov_b32 s9, 0
    s_mov_b32 s10, 0
    s_mov_b32 s11, 0
    s_mov_b32 s12, 0
    s_mov_b32 s13, 0
    s_mov_b32 s14, 0
    s_mov_b32 s15, 0
    s_atomic_or s8, s[62:63], 0 glc
    s_atomic_or s9, s[62:63], 4096 glc
    s_atomic_or s10, s[62:63], 8192 glc
    s_atomic_or s11, s[62:63], 12288 glc
    s_atomic_or s12, s[62:63], 16384 glc
    s_atomic_or s13, s[62:63], 20480 glc
    s_atomic_or s14, s[62:63], 24576 glc
    s_atomic_or s15, s[62:63], 28672 glc
    s_waitcnt lgkmcnt(0)
    s_xor_b32 s8, s8, s47
    s_xor_b32 s9, s9, s47
    s_xor_b32 s10, s10, s47
    s_xor_b32 s11, s11, s47
    s_xor_b32 s12, s12, s47
    s_xor_b32 s13, s13, s47
    s_xor_b32 s14, s14, s47
    s_xor_b32 s15, s15, s47
    s_or_b32 s8, s8, s9
    s_or_b32 s8, s8, s10
    s_or_b32 s8, s8, s11
    s_or_b32 s8, s8, s12
    s_or_b32 s8, s8, s13
    s_or_b32 s8, s8, s14
    s_or_b32 s8, s8, s15
    s_cbranch_scc0 Lgd_52
    s_sleep 4
    s_sub_u32 s46, s46, 1
    s_cbranch_scc0 Lgl_51
Lgd_52:
    ds_write_b32 v5, v6 offset:92
    s_cmp_lg_u32 s2, 0
    s_cbranch_scc1 Lep_53
    s_mov_b32 s8, s44
    s_atomic_swap s8, s[48:49], 0 glc
    s_waitcnt lgkmcnt(0)
Lep_53:
    s_endpgm
Lst_40:
    s_mov_b32 s46, 200000
Llp_42:
    s_sleep 2
    ds_read_b32 v8, v20
    s_waitcnt lgkmcnt(0)
    v_cmp_gt_u32 vcc, 1, v8
    s_cbranch_vccz Lrt_41
    s_sub_u32 s46, s46, 1
    s_cbranch_scc0 Llp_42
    s_branch Lrt_41
Lst_43:
    s_mov_b32 s46, 200000
Llp_45:
    s_sleep 4
    ds_read_b32 v8, v2
    s_waitcnt lgkmcnt(0)
    v_cmp_gt_u32 vcc, 1, v8
    s_cbranch_vccz Lrt_44
    s_sub_u32 s46, s46, 1
    s_cbranch_scc0 Llp_45
    s_branch Lrt_44
Lst_48:
    s_mov_b32 s46, 200000
Llp_50:
    s_sleep 4
    ds_read_b32 v8, v2
    s_waitcnt lgkmcnt(0)
    v_cmp_gt_u32 vcc, 2, v8
    s_cbranch_vccz Lrt_49
    s_sub_u32 s46, s46, 1
    s_cbranch_scc0 Llp_50
    s_branch Lrt_49
Lpb_37:
    s_lshl_b32 s50, s42, 3
    s_and_b32 s47, s43, 7
    s_add_u32 s50, s50, s47
    s_lshr_b32 s51, s43, 3
    s_bfe_u32 s53, s50, 0x20001
    s_bfe_u32 s54, s50, 0x10003
    s_lshr_b32 s55, s50, 4
    s_lshl_b32 s56, s55, 9
    s_lshl_b32 s47, s54, 6
    s_add_u32 s56, s56, s47
    s_lshl_b32 s47, s53, 3
    s_add_u32 s56, s56, s47
    s_mul_i32 s56, s56, 514
    v_bfe_u32 v10, v0, 3, 1
    v_bfe_u32 v11, v0, 4, 2
    v_lshl_add_u32 v10, v11, 2, v10
    v_mul_u32_u24 v6, 16448, v10
    v_and_b32 v10, 7, v0
    v_lshl_add_u32 v6, v10, 4, v6
    s_lshl_b32 s48, s51, 7
    s_add_u32 s58, s56, s48
    v_bfe_u32 v10, v0, 0, 1
    v_bfe_u32 v11, v0, 1, 2
    v_lshl_add_u32 v10, v11, 2, v10
    v_mul_u32_u24 v7, 16448, v10
    v_lshrrev_b32 v10, 3, v0
    v_mul_u32_u24 v10, 514, v10
    v_add_u32 v7, v7, v10
    v_and_b32 v2, 3, v0
    v_lshlrev_b32 v2, 2, v2
    v_add_u32 v2, 156464, v2
    s_waitcnt lgkmcnt(0)
    s_bitcmp1_b32 s50, 0
    s_cselect_b32 s12, s68, s66
    s_cselect_b32 s13, s69, s67
    s_mov_b32 s14, 1052672
    s_mov_b32 s15, 0x00020000
    s_mov_b32 s20, s82
    s_mov_b32 s21, s83
    s_mov_b32 s22, 16777216
    s_mov_b32 s23, 0x00020000
    buffer_load_dwordx4 v[40:43], v6, s[12:15], s58 offen offset:0 nt
    buffer_load_dwordx4 v[44:47], v6, s[12:15], s58 offen offset:514 nt
    buffer_load_dwordx4 v[48:51], v6, s[12:15], s58 offen offset:1028 nt
    buffer_load_dwordx4 v[52:55], v6, s[12:15], s58 offen offset:1542 nt
    buffer_load_dwordx4 v[56:59], v6, s[12:15], s58 offen offset:2056 nt
    buffer_load_dwordx4 v[60:63], v6, s[12:15], s58 offen offset:2570 nt
    buffer_load_dwordx4 v[64:67], v6, s[12:15], s58 offen offset:3084 nt
    buffer_load_dwordx4 v[68:71], v6, s[12:15], s58 offen offset:3598 nt
    s_cmp_lg_u32 s51, 0
    s_cbranch_scc1 Lc256_54
    buffer_load_ushort v36, v7, s[12:15], s56 offen offset:512
Lc256_54:
    s_setprio 1
    s_lshl_b32 s57, s55, 11
    s_and_b32 s47, s50, 1
    s_lshl_b32 s47, s47, 10
    s_add_u32 s57, s57, s47
    s_lshl_b32 s47, s54, 9
    s_add_u32 s57, s57, s47
    s_lshl_b32 s47, s53, 7
    s_add_u32 s57, s57, s47
    s_add_u32 s57, s57, 11534336
    s_mul_i32 s58, s51, 524288
    s_add_u32 s58, s58, s57
    v_lshrrev_b32 v12, 3, v0
    v_and_b32 v10, 3, v0
    v_lshlrev_b32 v8, 6, v12
    v_lshl_add_u32 v8, v10, 4, v8
    v_add_u32 v8, 156512, v8
    v_and_b32 v10, 7, v0
    v_mul_u32_u24 v9, 528, v10
    v_lshl_add_u32 v9, v12, 1, v9
    v_add_u32 v9, 156512, v9
    v_mul_u32_u24 v12, 8192, v12
    v_lshl_add_u32 v12, v10, 4, v12
    s_mov_b32 exec_lo, 0x0f0f0f0f
    s_mov_b32 exec_hi, 0x0f0f0f0f
    s_waitcnt vmcnt(7)
    ds_write_b128 v8, v[40:43] offset:0
    s_waitcnt vmcnt(6)
    ds_write_b128 v8, v[44:47] offset:528
    s_waitcnt vmcnt(5)
    ds_write_b128 v8, v[48:51] offset:1056
    s_waitcnt vmcnt(4)
    ds_write_b128 v8, v[52:55] offset:1584
    s_waitcnt vmcnt(3)
    ds_write_b128 v8, v[56:59] offset:2112
    s_waitcnt vmcnt(2)
    ds_write_b128 v8, v[60:63] offset:2640
    s_waitcnt vmcnt(1)
    ds_write_b128 v8, v[64:67] offset:3168
    s_waitcnt vmcnt(0)
    ds_write_b128 v8, v[68:71] offset:3696
    s_mov_b64 exec, -1
    ds_read_u16 v80, v9 offset:0
    ds_read_u16 v81, v9 offset:64
    ds_read_u16 v82, v9 offset:128
    ds_read_u16 v83, v9 offset:192
    ds_read_u16 v84, v9 offset:256
    ds_read_u16 v85, v9 offset:320
    ds_read_u16 v86, v9 offset:384
    ds_read_u16 v87, v9 offset:448
    ds_read_u16 v88, v9 offset:16
    ds_read_u16 v89, v9 offset:80
    ds_read_u16 v90, v9 offset:144
    ds_read_u16 v91, v9 offset:208
    ds_read_u16 v92, v9 offset:272
    ds_read_u16 v93, v9 offset:336
    ds_read_u16 v94, v9 offset:400
    ds_read_u16 v95, v9 offset:464
    ds_read_u16 v96, v9 offset:32
    ds_read_u16 v97, v9 offset:96
    ds_read_u16 v98, v9 offset:160
    ds_read_u16 v99, v9 offset:224
    ds_read_u16 v100, v9 offset:288
    ds_read_u16 v101, v9 offset:352
    ds_read_u16 v102, v9 offset:416
    ds_read_u16 v103, v9 offset:480
    ds_read_u16 v104, v9 offset:48
    ds_read_u16 v105, v9 offset:112
    ds_read_u16 v106, v9 offset:176
    ds_read_u16 v107, v9 offset:240
    ds_read_u16 v108, v9 offset:304
    ds_read_u16 v109, v9 offset:368
    ds_read_u16 v110, v9 offset:432
    ds_read_u16 v111, v9 offset:496
    s_mov_b32 exec_lo, 0xf0f0f0f0
    s_mov_b32 exec_hi, 0xf0f0f0f0
    ds_write_b128 v8, v[40:43] offset:0
    ds_write_b128 v8, v[44:47] offset:528
    ds_write_b128 v8, v[48:51] offset:1056
    ds_write_b128 v8, v[52:55] offset:1584
    ds_write_b128 v8, v[56:59] offset:2112
    ds_write_b128 v8, v[60:63] offset:2640
    ds_write_b128 v8, v[64:67] offset:3168
    ds_write_b128 v8, v[68:71] offset:3696
    s_mov_b64 exec, -1
    ds_read_u16 v112, v9 offset:0
    ds_read_u16 v113, v9 offset:64
    ds_read_u16 v114, v9 offset:128
    ds_read_u16 v115, v9 offset:192
    ds_read_u16 v116, v9 offset:256
    ds_read_u16 v117, v9 offset:320
    ds_read_u16 v118, v9 offset:384
    ds_read_u16 v119, v9 offset:448
    ds_read_u16 v120, v9 offset:16
    ds_read_u16 v121, v9 offset:80
    ds_read_u16 v122, v9 offset:144
    ds_read_u16 v123, v9 offset:208
    ds_read_u16 v124, v9 offset:272
    ds_read_u16 v125, v9 offset:336
    ds_read_u16 v126, v9 offset:400
    ds_read_u16 v127, v9 offset:464
    ds_read_u16 v128, v9 offset:32
    ds_read_u16 v129, v9 offset:96
    ds_read_u16 v130, v9 offset:160
    ds_read_u16 v131, v9 offset:224
    ds_read_u16 v132, v9 offset:288
    ds_read_u16 v133, v9 offset:352
    ds_read_u16 v134, v9 offset:416
    ds_read_u16 v135, v9 offset:480
    ds_read_u16 v136, v9 offset:48
    ds_read_u16 v137, v9 offset:112
    ds_read_u16 v138, v9 offset:176
    ds_read_u16 v139, v9 offset:240
    ds_read_u16 v140, v9 offset:304
    ds_read_u16 v141, v9 offset:368
    ds_read_u16 v142, v9 offset:432
    ds_read_u16 v143, v9 offset:496
    s_waitcnt lgkmcnt(15)
    v_lshl_or_b32 v80, v81, 16, v80
    v_lshl_or_b32 v81, v83, 16, v82
    v_lshl_or_b32 v82, v85, 16, v84
    v_lshl_or_b32 v83, v87, 16, v86
    s_add_u32 s47, s58, 0
    buffer_store_dwordx4 v[80:83], v12, s[20:23], s47 offen sc1
    v_lshl_or_b32 v88, v89, 16, v88
    v_lshl_or_b32 v89, v91, 16, v90
    v_lshl_or_b32 v90, v93, 16, v92
    v_lshl_or_b32 v91, v95, 16, v94
    s_add_u32 s47, s58, 65536
    buffer_store_dwordx4 v[88:91], v12, s[20:23], s47 offen sc1
    v_lshl_or_b32 v96, v97, 16, v96
    v_lshl_or_b32 v97, v99, 16, v98
    v_lshl_or_b32 v98, v101, 16, v100
    v_lshl_or_b32 v99, v103, 16, v102
    s_add_u32 s47, s58, 131072
    buffer_store_dwordx4 v[96:99], v12, s[20:23], s47 offen sc1
    v_lshl_or_b32 v104, v105, 16, v104
    v_lshl_or_b32 v105, v107, 16, v106
    v_lshl_or_b32 v106, v109, 16, v108
    v_lshl_or_b32 v107, v111, 16, v110
    s_add_u32 s47, s58, 196608
    buffer_store_dwordx4 v[104:107], v12, s[20:23], s47 offen sc1
    v_lshl_or_b32 v112, v113, 16, v112
    v_lshl_or_b32 v113, v115, 16, v114
    v_lshl_or_b32 v114, v117, 16, v116
    v_lshl_or_b32 v115, v119, 16, v118
    s_add_u32 s47, s58, 262144
    buffer_store_dwordx4 v[112:115], v12, s[20:23], s47 offen sc1
    v_lshl_or_b32 v120, v121, 16, v120
    v_lshl_or_b32 v121, v123, 16, v122
    v_lshl_or_b32 v122, v125, 16, v124
    v_lshl_or_b32 v123, v127, 16, v126
    s_add_u32 s47, s58, 327680
    buffer_store_dwordx4 v[120:123], v12, s[20:23], s47 offen sc1
    s_waitcnt lgkmcnt(14)
    v_lshl_or_b32 v128, v129, 16, v128
    s_waitcnt lgkmcnt(12)
    v_lshl_or_b32 v129, v131, 16, v130
    s_waitcnt lgkmcnt(10)
    v_lshl_or_b32 v130, v133, 16, v132
    s_waitcnt lgkmcnt(8)
    v_lshl_or_b32 v131, v135, 16, v134
    s_add_u32 s47, s58, 393216
    buffer_store_dwordx4 v[128:131], v12, s[20:23], s47 offen sc1
    s_waitcnt lgkmcnt(6)
    v_lshl_or_b32 v136, v137, 16, v136
    s_waitcnt lgkmcnt(4)
    v_lshl_or_b32 v137, v139, 16, v138
    s_waitcnt lgkmcnt(2)
    v_lshl_or_b32 v138, v141, 16, v140
    s_waitcnt lgkmcnt(0)
    v_lshl_or_b32 v139, v143, 16, v142
    s_add_u32 s47, s58, 458752
    buffer_store_dwordx4 v[136:139], v12, s[20:23], s47 offen sc1
    s_cmp_lg_u32 s51, 0
    s_cbranch_scc1 Lc256s_55
    s_add_u32 s47, s57, 2097152
    v_lshlrev_b32 v10, 1, v0
    s_waitcnt vmcnt(8)
    buffer_store_short v36, v10, s[20:23], s47 offen sc1
Lc256s_55:
    s_setprio 3
    v_mov_b32 v8, 156496
    s_waitcnt vmcnt(0)
    v_mov_b32 v9, 1
    ds_write_b32 v8, v9
    s_lshr_b32 s50, s42, 2
    s_lshl_b32 s50, s50, 3
    s_and_b32 s47, s43, 7
    s_add_u32 s50, s50, s47
    s_and_b32 s51, s42, 3
    s_lshl_b32 s51, s51, 2
    s_lshr_b32 s47, s43, 3
    s_add_u32 s51, s51, s47
    s_lshl_b32 s52, s50, 8
    s_add_u32 s54, s52, 14745600
    s_add_u32 s54, s82, s54
    s_addc_u32 s55, s83, 0
    s_lshl_b32 s52, s51, 8
    s_add_u32 s4, s52, 14749696
    s_add_u32 s4, s82, s4
    s_addc_u32 s5, s83, 0
    s_lshl_b32 s6, s51, 12
    s_add_u32 s6, s6, 15007744
    v_lshlrev_b32 v4, 4, v0
    s_lshl_b32 s52, s50, 11
    s_add_u32 s52, s52, 14974976
    v_mov_b32 v5, 156256
    v_mov_b32 v6, 1
    v_and_b32 v2, 3, v0
    v_lshlrev_b32 v2, 2, v2
    v_add_u32 v2, 156432, v2
    s_and_b32 s47, s43, 3
    s_lshl2_add_u32 s50, s42, s47
    s_lshr_b32 s51, s43, 2
    s_mul_i32 s53, s50, 12
    s_and_b32 s47, s51, 1
    s_add_u32 s53, s53, s47
    s_lshl_b32 s53, s53, 8
    s_add_u32 s56, s53, 15073280
    s_add_u32 s56, s82, s56
    s_addc_u32 s57, s83, 0
    v_mov_b32 v8, 156340
    ds_read_b32 v9, v8
    s_waitcnt lgkmcnt(0)
    v_cmp_gt_u32 vcc, 1, v9
    s_cbranch_vccnz Lst_56
Lrt_57:
    ds_read_b32 v9, v8 offset:44
    s_waitcnt lgkmcnt(0)
    v_readfirstlane_b32 s44, v9
    ds_read_b32 v8, v2
    s_waitcnt lgkmcnt(0)
    v_cmp_gt_u32 vcc, 1, v8
    s_cbranch_vccnz Lst_59
Lrt_60:
    s_or_b32 s47, s2, 60
    s_cmp_eq_u32 s47, 0xff
    s_cbranch_scc1 Lpb_62
    s_add_u32 s47, s44, 16
    s_mov_b32 s46, 60000
Lgl_63:
    s_mov_b32 s58, 0
    s_atomic_or s58, s[54:55], 0 glc
    s_waitcnt lgkmcnt(0)
    s_xor_b32 s58, s58, s47
    s_cbranch_scc0 Lgd_64
    s_sleep 4
    s_sub_u32 s46, s46, 1
    s_cbranch_scc0 Lgl_63
Lgd_64:
    buffer_load_dwordx4 v[8:11], v4, s[20:23], s52 offen sc1
    buffer_load_dwordx4 v[12:15], v4, s[20:23], s52 offen offset:1024 sc1
    v_add_u32 v7, 156512, v4
    s_waitcnt vmcnt(1)
    ds_write_b128 v7, v[8:11]
    s_waitcnt vmcnt(0)
    ds_write_b128 v7, v[12:15] offset:1024
    s_add_u32 s47, s44, 4
    s_mov_b32 s46, 60000
Lgl_65:
    s_mov_b32 s58, 0
    s_atomic_or s58, s[4:5], 0 glc
    s_waitcnt lgkmcnt(0)
    s_xor_b32 s58, s58, s47
    s_cbranch_scc0 Lgd_66
    s_sleep 4
    s_sub_u32 s46, s46, 1
    s_cbranch_scc0 Lgl_65
Lgd_66:
    buffer_load_dwordx4 v[16:19], v4, s[20:23], s6 offen offset:0 sc1
    buffer_load_dwordx4 v[20:23], v4, s[20:23], s6 offen offset:1024 sc1
    buffer_load_dwordx4 v[24:27], v4, s[20:23], s6 offen offset:2048 sc1
    s_waitcnt vmcnt(2)
    ds_write_b128 v7, v[16:19] offset:2048
    s_waitcnt vmcnt(1)
    ds_write_b128 v7, v[20:23] offset:3072
    s_waitcnt vmcnt(0)
    ds_write_b128 v7, v[24:27] offset:4096
    ds_write_b32 v5, v6 offset:80
    v_and_b32 v2, 3, v0
    v_lshlrev_b32 v2, 2, v2
    v_add_u32 v2, 156448, v2
    ds_read_b32 v8, v2
    s_waitcnt lgkmcnt(0)
    v_cmp_gt_u32 vcc, 1, v8
    s_cbranch_vccnz Lst_67
Lrt_68:
    s_waitcnt vmcnt(0) lgkmcnt(0)
Lpb_62:
    s_add_u32 s47, s44, 15
    s_mov_b32 s46, 60000
Lhl_70:
    s_mov_b32 s58, 0
    s_mov_b32 s59, 0
    s_mov_b32 s60, 0
    s_mov_b32 s61, 0
    s_mov_b32 s62, 0
    s_mov_b32 s63, 0
    s_atomic_or s58, s[56:57], 0 glc
    s_atomic_or s59, s[56:57], 512 glc
    s_atomic_or s60, s[56:57], 1024 glc
    s_atomic_or s61, s[56:57], 1536 glc
    s_atomic_or s62, s[56:57], 2048 glc
    s_atomic_or s63, s[56:57], 2560 glc
    s_waitcnt lgkmcnt(0)
    s_cmp_eq_u32 s60, s47
    s_cselect_b32 s52, 3, 2
    s_cmp_eq_u32 s59, s47
    s_cselect_b32 s52, s52, 1
    s_cmp_eq_u32 s58, s47
    s_cselect_b32 s52, s52, 0
    v_mov_b32 v8, s52
    s_cmp_eq_u32 s63, s47
    s_cselect_b32 s53, 3, 2
    s_cmp_eq_u32 s62, s47
    s_cselect_b32 s53, s53, 1
    s_cmp_eq_u32 s61, s47
    s_cselect_b32 s53, s53, 0
    v_mov_b32 v9, s53
    ds_write_b64 v5, v[8:9] offset:160
    s_and_b32 s52, s52, s53
    s_cmp_eq_u32 s52, 3
    s_cbranch_scc1 Lhd_71
    s_sleep 4
    s_sub_u32 s46, s46, 1
    s_cbranch_scc0 Lhl_70
    v_mov_b32 v8, 3
    v_mov_b32 v9, 3
    ds_write_b64 v5, v[8:9] offset:160
Lhd_71:
    s_waitcnt lgkmcnt(0)
    s_endpgm
Lst_56:
    s_mov_b32 s46, 200000
Llp_58:
    s_sleep 1
    ds_read_b32 v9, v8
    s_waitcnt lgkmcnt(0)
    v_cmp_gt_u32 vcc, 1, v9
    s_cbranch_vccz Lrt_57
    s_sub_u32 s46, s46, 1
    s_cbranch_scc0 Llp_58
    s_branch Lrt_57
Lst_59:
    s_mov_b32 s46, 200000
Llp_61:
    s_sleep 4
    ds_read_b32 v8, v2
    s_waitcnt lgkmcnt(0)
    v_cmp_gt_u32 vcc, 1, v8
    s_cbranch_vccz Lrt_60
    s_sub_u32 s46, s46, 1
    s_cbranch_scc0 Llp_61
    s_branch Lrt_60
Lst_67:
    s_mov_b32 s46, 200000
Llp_69:
    s_sleep 4
    ds_read_b32 v8, v2
    s_waitcnt lgkmcnt(0)
    v_cmp_gt_u32 vcc, 1, v8
    s_cbranch_vccz Lrt_68
    s_sub_u32 s46, s46, 1
    s_cbranch_scc0 Llp_69
    s_branch Lrt_68
Lspec_3:
    s_setprio 1
    s_lshl_b32 s47, s41, 2
    s_add_u32 s47, s47, 156320
    v_mov_b32 v1, s47
    v_and_b32 v10, 3, v0
    v_lshlrev_b32 v2, 2, v10
    v_add_u32 v2, 156320, v2
    v_and_b32 v10, 1, v0
    s_mov_b32 s47, 0x80008000
    v_mul_lo_u32 v4, v10, s47
    s_lshl_b32 s50, s42, 3
    s_and_b32 s47, s43, 7
    s_add_u32 s50, s50, s47
    s_lshr_b32 s51, s43, 3
    s_lshl2_add_u32 s52, s51, s41
    v_lshlrev_b32 v5, 4, v0
    s_lshl_b32 s53, s41, 19
    s_lshl_b32 s48, s50, 10
    s_add_u32 s53, s53, s48
    s_mul_i32 s54, s41, 8320
    v_bfe_u32 v10, v0, 1, 4
    s_lshl_b32 s47, s52, 4
    v_add_u32 v11, s47, v10
    v_and_b32 v12, 1, v0
    v_lshl_add_u32 v13, v11, 1, v12
    v_cmp_eq_u32 vcc, 1, v13
    v_mov_b32 v14, 0x100
    s_nop 0
    v_cndmask_b32 v11, v11, v14, vcc
    v_cndmask_b32 v14, v12, 0, vcc
    v_cvt_f32_u32 v11, v11
    v_cvt_f32_u32 v14, v14
    v_mul_f32 v8, 0x3b000000, v11
    v_lshrrev_b32 v15, 5, v0
    v_cvt_f32_u32 v15, v15
    v_mul_f32 v9, 0x41000000, v15
    v_mul_f32 v9, v9, v8
    v_fmamk_f32 v9, v14, 0x3e800000, v9
    v_mov_b32 v96, v9
    v_fmamk_f32 v97, v8, 0x3f800000, v9
    v_cos_f32 v98, v96
    v_cos_f32 v99, v97
    v_fmamk_f32 v100, v8, 0x40000000, v9
    v_fmamk_f32 v101, v8, 0x40400000, v9
    v_cos_f32 v102, v100
    v_cos_f32 v103, v101
    v_cvt_pk_bf16_f32 v16, v98, v99
    v_fmamk_f32 v96, v8, 0x40800000, v9
    v_fmamk_f32 v97, v8, 0x40a00000, v9
    v_cos_f32 v98, v96
    v_cos_f32 v99, v97
    v_cvt_pk_bf16_f32 v17, v102, v103
    v_fmamk_f32 v100, v8, 0x40c00000, v9
    v_fmamk_f32 v101, v8, 0x40e00000, v9
    v_cos_f32 v102, v100
    v_cos_f32 v103, v101
    v_cvt_pk_bf16_f32 v18, v98, v99
    v_fmamk_f32 v96, v8, 0x41800000, v9
    v_fmamk_f32 v97, v8, 0x41880000, v9
    v_cos_f32 v98, v96
    v_cos_f32 v99, v97
    v_cvt_pk_bf16_f32 v19, v102, v103
    v_fmamk_f32 v100, v8, 0x41900000, v9
    v_fmamk_f32 v101, v8, 0x41980000, v9
    v_cos_f32 v102, v100
    v_cos_f32 v103, v101
    v_cvt_pk_bf16_f32 v20, v98, v99
    v_fmamk_f32 v96, v8, 0x41a00000, v9
    v_fmamk_f32 v97, v8, 0x41a80000, v9
    v_cos_f32 v98, v96
    v_cos_f32 v99, v97
    v_cvt_pk_bf16_f32 v21, v102, v103
    v_fmamk_f32 v100, v8, 0x41b00000, v9
    v_fmamk_f32 v101, v8, 0x41b80000, v9
    v_cos_f32 v102, v100
    v_cos_f32 v103, v101
    v_cvt_pk_bf16_f32 v22, v98, v99
    v_fmamk_f32 v96, v8, 0x42000000, v9
    v_fmamk_f32 v97, v8, 0x42040000, v9
    v_cos_f32 v98, v96
    v_cos_f32 v99, v97
    v_cvt_pk_bf16_f32 v23, v102, v103
    v_fmamk_f32 v100, v8, 0x42080000, v9
    v_fmamk_f32 v101, v8, 0x420c0000, v9
    v_cos_f32 v102, v100
    v_cos_f32 v103, v101
    v_cvt_pk_bf16_f32 v24, v98, v99
    v_fmamk_f32 v96, v8, 0x42100000, v9
    v_fmamk_f32 v97, v8, 0x42140000, v9
    v_cos_f32 v98, v96
    v_cos_f32 v99, v97
    v_cvt_pk_bf16_f32 v25, v102, v103
    v_fmamk_f32 v100, v8, 0x42180000, v9
    v_fmamk_f32 v101, v8, 0x421c0000, v9
    v_cos_f32 v102, v100
    v_cos_f32 v103, v101
    v_cvt_pk_bf16_f32 v26, v98, v99
    v_fmamk_f32 v96, v8, 0x42400000, v9
    v_fmamk_f32 v97, v8, 0x42440000, v9
    v_cos_f32 v98, v96
    v_cos_f32 v99, v97
    v_cvt_pk_bf16_f32 v27, v102, v103
    v_fmamk_f32 v100, v8, 0x42480000, v9
    v_fmamk_f32 v101, v8, 0x424c0000, v9
    v_cos_f32 v102, v100
    v_cos_f32 v103, v101
    v_cvt_pk_bf16_f32 v28, v98, v99
    v_fmamk_f32 v96, v8, 0x42500000, v9
    v_fmamk_f32 v97, v8, 0x42540000, v9
    v_cos_f32 v98, v96
    v_cos_f32 v99, v97
    v_cvt_pk_bf16_f32 v29, v102, v103
    v_fmamk_f32 v100, v8, 0x42580000, v9
    v_fmamk_f32 v101, v8, 0x425c0000, v9
    v_cos_f32 v102, v100
    v_cos_f32 v103, v101
    v_cvt_pk_bf16_f32 v30, v98, v99
    v_fmamk_f32 v96, v8, 0x42800000, v9
    v_fmamk_f32 v97, v8, 0x42820000, v9
    v_cos_f32 v98, v96
    v_cos_f32 v99, v97
    v_cvt_pk_bf16_f32 v31, v102, v103
    v_fmamk_f32 v100, v8, 0x42840000, v9
    v_fmamk_f32 v101, v8, 0x42860000, v9
    v_cos_f32 v102, v100
    v_cos_f32 v103, v101
    v_cvt_pk_bf16_f32 v32, v98, v99
    v_fmamk_f32 v96, v8, 0x42880000, v9
    v_fmamk_f32 v97, v8, 0x428a0000, v9
    v_cos_f32 v98, v96
    v_cos_f32 v99, v97
    v_cvt_pk_bf16_f32 v33, v102, v103
    v_fmamk_f32 v100, v8, 0x428c0000, v9
    v_fmamk_f32 v101, v8, 0x428e0000, v9
    v_cos_f32 v102, v100
    v_cos_f32 v103, v101
    v_cvt_pk_bf16_f32 v34, v98, v99
    v_fmamk_f32 v96, v8, 0x42a00000, v9
    v_fmamk_f32 v97, v8, 0x42a20000, v9
    v_cos_f32 v98, v96
    v_cos_f32 v99, v97
    v_cvt_pk_bf16_f32 v35, v102, v103
    v_fmamk_f32 v100, v8, 0x42a40000, v9
    v_fmamk_f32 v101, v8, 0x42a60000, v9
    v_cos_f32 v102, v100
    v_cos_f32 v103, v101
    v_cvt_pk_bf16_f32 v36, v98, v99
    v_fmamk_f32 v96, v8, 0x42a80000, v9
    v_fmamk_f32 v97, v8, 0x42aa0000, v9
    v_cos_f32 v98, v96
    v_cos_f32 v99, v97
    v_cvt_pk_bf16_f32 v37, v102, v103
    v_fmamk_f32 v100, v8, 0x42ac0000, v9
    v_fmamk_f32 v101, v8, 0x42ae0000, v9
    v_cos_f32 v102, v100
    v_cos_f32 v103, v101
    v_cvt_pk_bf16_f32 v38, v98, v99
    v_fmamk_f32 v96, v8, 0x42c00000, v9
    v_fmamk_f32 v97, v8, 0x42c20000, v9
    v_cos_f32 v98, v96
    v_cos_f32 v99, v97
    v_cvt_pk_bf16_f32 v39, v102, v103
    v_fmamk_f32 v100, v8, 0x42c40000, v9
    v_fmamk_f32 v101, v8, 0x42c60000, v9
    v_cos_f32 v102, v100
    v_cos_f32 v103, v101
    v_cvt_pk_bf16_f32 v40, v98, v99
    v_fmamk_f32 v96, v8, 0x42c80000, v9
    v_fmamk_f32 v97, v8, 0x42ca0000, v9
    v_cos_f32 v98, v96
    v_cos_f32 v99, v97
    v_cvt_pk_bf16_f32 v41, v102, v103
    v_fmamk_f32 v100, v8, 0x42cc0000, v9
    v_fmamk_f32 v101, v8, 0x42ce0000, v9
    v_cos_f32 v102, v100
    v_cos_f32 v103, v101
    v_cvt_pk_bf16_f32 v42, v98, v99
    v_fmamk_f32 v96, v8, 0x42e00000, v9
    v_fmamk_f32 v97, v8, 0x42e20000, v9
    v_cos_f32 v98, v96
    v_cos_f32 v99, v97
    v_cvt_pk_bf16_f32 v43, v102, v103
    v_fmamk_f32 v100, v8, 0x42e40000, v9
    v_fmamk_f32 v101, v8, 0x42e60000, v9
    v_cos_f32 v102, v100
    v_cos_f32 v103, v101
    v_cvt_pk_bf16_f32 v44, v98, v99
    v_fmamk_f32 v96, v8, 0x42e80000, v9
    v_fmamk_f32 v97, v8, 0x42ea0000, v9
    v_cos_f32 v98, v96
    v_cos_f32 v99, v97
    v_cvt_pk_bf16_f32 v45, v102, v103
    v_fmamk_f32 v100, v8, 0x42ec0000, v9
    v_fmamk_f32 v101, v8, 0x42ee0000, v9
    v_cos_f32 v102, v100
    v_cos_f32 v103, v101
    v_cvt_pk_bf16_f32 v46, v98, v99
    v_cvt_pk_bf16_f32 v47, v102, v103
    s_waitcnt lgkmcnt(0)
    s_mov_b32 s20, s82
    s_mov_b32 s21, s83
    s_mov_b32 s22, 16777216
    s_mov_b32 s23, 0x00020000
    v_cvt_f32_u32 v10, v10
    v_cvt_f32_u32 v12, v12
    v_mul_f32 v10, 0x3e800000, v10
    v_cos_f32 v164, v10
    v_fma_f32 v11, v12, 0.5, v10
    v_sin_f32 v165, v11
    v_bfe_u32 v10, v0, 1, 1
    s_mov_b32 s47, 0x80008000
    v_mul_lo_u32 v166, v10, s47
    v_rndne_f32 v164, v164
    v_rndne_f32 v165, v165
    v_cmp_eq_u32 vcc, 0, v13
    v_mov_b32 v11, 0x44000000
    s_nop 0
    v_cndmask_b32 v167, 0, v11, vcc
    v_and_b32 v10, 31, v0
    v_cvt_f32_u32 v10, v10
    v_mul_f32 v8, 0x3d000000, v10
    v_cvt_f32_u32 v11, s50
    v_mul_f32 v11, v11, v10
    v_mul_f32 v9, 0x3a000000, v11
    v_mul_f32 v11, 4.0, v15
    v_fmac_f32 v9, v11, v8
    v_mov_b32 v96, v9
    v_cos_f32 v97, v96
    v_sin_f32 v98, v96
    v_fmamk_f32 v99, v8, 0x3f800000, v9
    v_cos_f32 v100, v99
    v_sin_f32 v101, v99
    v_cvt_pk_bf16_f32 v48, v97, v100
    v_cvt_pk_bf16_f32 v56, v98, v101
    v_fmamk_f32 v96, v8, 0x40000000, v9
    v_cos_f32 v97, v96
    v_sin_f32 v98, v96
    v_fmamk_f32 v99, v8, 0x40400000, v9
    v_cos_f32 v100, v99
    v_sin_f32 v101, v99
    v_cvt_pk_bf16_f32 v49, v97, v100
    v_cvt_pk_bf16_f32 v57, v98, v101
    s_mov_b32 s47, 0x80008000
    v_bfe_u32 v96, v0, 1, 1
    v_mul_lo_u32 v96, v96, s47
    v_xor_b32 v97, v96, v4
    s_mov_b32 vcc_lo, 0xaaaaaaaa
    s_mov_b32 vcc_hi, 0xaaaaaaaa
    v_cndmask_b32 v50, v48, v56, vcc
    v_cndmask_b32 v58, v56, v48, vcc
    v_cndmask_b32 v51, v49, v57, vcc
    v_cndmask_b32 v59, v57, v49, vcc
    v_xor_b32 v50, v97, v50
    v_xor_b32 v58, v96, v58
    v_xor_b32 v51, v97, v51
    v_xor_b32 v59, v96, v59
    v_xor_b32 v52, v4, v48
    v_xor_b32 v60, v4, v56
    v_xor_b32 v53, v4, v49
    v_xor_b32 v61, v4, v57
    v_xor_b32 v54, v4, v50
    v_xor_b32 v62, v4, v58
    v_xor_b32 v55, v4, v51
    v_xor_b32 v63, v4, v59
    v_and_b32 v10, 31, v0
    v_mul_u32_u24 v8, 1040, v10
    v_lshrrev_b32 v11, 5, v0
    v_lshl_add_u32 v8, v11, 4, v8
    v_add_u32 v8, 122976, v8
    v_lshlrev_b32 v9, 4, v11
    v_add_u32 v9, 161632, v9
    v_lshlrev_b32 v13, 2, v10
    v_mul_u32_u24 v12, 16384, v11
    v_add_u32 v13, v12, v13
    v_and_b32 v12, 7, v0
    v_lshlrev_b32 v12, 4, v12
    s_lshl_b32 s47, s41, 7
    v_add_u32 v12, s47, v12
    v_add_u32 v14, 161888, v12
    v_add_u32 v6, 160, v2
    v_mov_b32 v7, 156496
    s_mul_i32 s53, s52, 131072
    s_lshl_b32 s47, s50, 7
    s_add_u32 s53, s53, s47
    s_add_u32 s53, s53, 6291456
    s_lshl_b32 s54, s50, 9
    s_add_u32 s54, s54, 14974976
    s_cmp_eq_u32 s51, 0
    s_cselect_b32 s54, s54, 0x7f000000
    s_and_b32 s47, s50, 3
    s_lshl2_add_u32 s47, s52, s47
    s_lshl_b32 s47, s47, 10
    s_add_u32 s60, s47, 14680064
    s_add_u32 s60, s82, s60
    s_addc_u32 s61, s83, 0
    s_lshr_b32 s47, s50, 2
    s_lshl_b32 s47, s47, 8
    s_add_u32 s62, s47, 14745600
    s_add_u32 s62, s82, s62
    s_addc_u32 s63, s83, 0
    s_mov_b32 s55, 1
    s_mov_b32 s56, 1
    s_mov_b32 s57, 1
    s_mov_b32 s58, 1
    s_setprio 3
    ds_read_b32 v3, v2
    s_waitcnt lgkmcnt(0)
    v_cmp_gt_u32 vcc, 1, v3
    s_cbranch_vccnz Lst_72
Lrt_73:
    ds_read_b128 v[96:99], v8 offset:0
    ds_read_b128 v[100:103], v8 offset:32
    ds_read_b128 v[104:107], v8 offset:64
    ds_read_b128 v[108:111], v8 offset:96
    ds_read_b128 v[112:115], v8 offset:128
    ds_read_b128 v[116:119], v8 offset:160
    ds_read_b128 v[120:123], v8 offset:192
    s_waitcnt lgkmcnt(6)
    v_mfma_f32_32x32x16_bf16 v[64:79], v[96:99], v[16:19], 0
    ds_read_b128 v[124:127], v8 offset:224
    s_waitcnt lgkmcnt(6)
    v_mfma_f32_32x32x16_bf16 v[64:79], v[100:103], v[20:23], v[64:79]
    ds_read_b128 v[96:99], v8 offset:256
    s_waitcnt lgkmcnt(6)
    v_mfma_f32_32x32x16_bf16 v[64:79], v[104:107], v[24:27], v[64:79]
    ds_read_b128 v[100:103], v8 offset:288
    s_waitcnt lgkmcnt(6)
    v_mfma_f32_32x32x16_bf16 v[64:79], v[108:111], v[28:31], v[64:79]
    ds_read_b128 v[104:107], v8 offset:320
    s_waitcnt lgkmcnt(6)
    v_mfma_f32_32x32x16_bf16 v[64:79], v[112:115], v[32:35], v[64:79]
    ds_read_b128 v[108:111], v8 offset:352
    s_waitcnt lgkmcnt(6)
    v_mfma_f32_32x32x16_bf16 v[64:79], v[116:119], v[36:39], v[64:79]
    ds_read_b128 v[112:115], v8 offset:384
    s_waitcnt lgkmcnt(6)
    v_mfma_f32_32x32x16_bf16 v[64:79], v[120:123], v[40:43], v[64:79]
    ds_read_b128 v[116:119], v8 offset:416
    s_waitcnt lgkmcnt(6)
    v_mfma_f32_32x32x16_bf16 v[64:79], v[124:127], v[44:47], v[64:79]
    ds_read_b128 v[120:123], v8 offset:448
    s_waitcnt lgkmcnt(6)
    v_mfma_f32_32x32x16_bf16 v[80:95], v[96:99], v[16:19], 0
    ds_read_b128 v[124:127], v8 offset:480
    v_xor_b32 v16, v166, v16
    v_xor_b32 v17, v166, v17
    v_xor_b32 v18, v166, v18
    v_xor_b32 v19, v166, v19
    s_waitcnt lgkmcnt(6)
    v_mfma_f32_32x32x16_bf16 v[80:95], v[100:103], v[20:23], v[80:95]
    ds_read_b128 v[96:99], v8 offset:512
    v_xor_b32 v20, v166, v20
    v_xor_b32 v21, v166, v21
    v_xor_b32 v22, v166, v22
    v_xor_b32 v23, v166, v23
    s_waitcnt lgkmcnt(6)
    v_mfma_f32_32x32x16_bf16 v[80:95], v[104:107], v[24:27], v[80:95]
    ds_read_b128 v[100:103], v8 offset:544
    v_xor_b32 v24, v166, v24
    v_xor_b32 v25, v166, v25
    v_xor_b32 v26, v166, v26
    v_xor_b32 v27, v166, v27
    s_waitcnt lgkmcnt(6)
    v_mfma_f32_32x32x16_bf16 v[80:95], v[108:111], v[28:31], v[80:95]
    ds_read_b128 v[104:107], v8 offset:576
    v_xor_b32 v28, v166, v28
    v_xor_b32 v29, v166, v29
    v_xor_b32 v30, v166, v30
    v_xor_b32 v31, v166, v31
    s_waitcnt lgkmcnt(6)
    v_mfma_f32_32x32x16_bf16 v[80:95], v[112:115], v[32:35], v[80:95]
    ds_read_b128 v[108:111], v8 offset:608
    v_xor_b32 v32, v166, v32
    v_xor_b32 v33, v166, v33
    v_xor_b32 v34, v166, v34
    v_xor_b32 v35, v166, v35
    s_waitcnt lgkmcnt(6)
    v_mfma_f32_32x32x16_bf16 v[80:95], v[116:119], v[36:39], v[80:95]
    ds_read_b128 v[112:115], v8 offset:640
    v_xor_b32 v36, v166, v36
    v_xor_b32 v37, v166, v37
    v_xor_b32 v38, v166, v38
    v_xor_b32 v39, v166, v39
    s_waitcnt lgkmcnt(6)
    v_mfma_f32_32x32x16_bf16 v[80:95], v[120:123], v[40:43], v[80:95]
    ds_read_b128 v[116:119], v8 offset:672
    v_xor_b32 v40, v166, v40
    v_xor_b32 v41, v166, v41
    v_xor_b32 v42, v166, v42
    v_xor_b32 v43, v166, v43
    s_waitcnt lgkmcnt(6)
    v_mfma_f32_32x32x16_bf16 v[80:95], v[124:127], v[44:47], v[80:95]
    ds_read_b128 v[120:123], v8 offset:704
    v_xor_b32 v44, v166, v44
    v_xor_b32 v45, v166, v45
    v_xor_b32 v46, v166, v46
    v_xor_b32 v47, v166, v47
    s_waitcnt lgkmcnt(6)
    v_mfma_f32_32x32x16_bf16 v[64:79], v[96:99], v[16:19], v[64:79]
    ds_read_b128 v[124:127], v8 offset:736
    s_waitcnt lgkmcnt(6)
    v_mfma_f32_32x32x16_bf16 v[64:79], v[100:103], v[20:23], v[64:79]
    ds_read_b128 v[96:99], v8 offset:768
    s_waitcnt lgkmcnt(6)
    v_mfma_f32_32x32x16_bf16 v[64:79], v[104:107], v[24:27], v[64:79]
    ds_read_b128 v[100:103], v8 offset:800
    s_waitcnt lgkmcnt(6)
    v_mfma_f32_32x32x16_bf16 v[64:79], v[108:111], v[28:31], v[64:79]
    ds_read_b128 v[104:107], v8 offset:832
    s_waitcnt lgkmcnt(6)
    v_mfma_f32_32x32x16_bf16 v[64:79], v[112:115], v[32:35], v[64:79]
    ds_read_b128 v[108:111], v8 offset:864
    s_waitcnt lgkmcnt(6)
    v_mfma_f32_32x32x16_bf16 v[64:79], v[116:119], v[36:39], v[64:79]
    ds_read_b128 v[112:115], v8 offset:896
    s_waitcnt lgkmcnt(6)
    v_mfma_f32_32x32x16_bf16 v[64:79], v[120:123], v[40:43], v[64:79]
    ds_read_b128 v[116:119], v8 offset:928
    s_waitcnt lgkmcnt(6)
    v_mfma_f32_32x32x16_bf16 v[64:79], v[124:127], v[44:47], v[64:79]
    ds_read_b128 v[120:123], v8 offset:960
    s_waitcnt lgkmcnt(6)
    v_mfma_f32_32x32x16_bf16 v[80:95], v[96:99], v[16:19], v[80:95]
    ds_read_b128 v[124:127], v8 offset:992
    s_waitcnt lgkmcnt(6)
    v_mfma_f32_32x32x16_bf16 v[80:95], v[100:103], v[20:23], v[80:95]
    s_waitcnt lgkmcnt(5)
    v_mfma_f32_32x32x16_bf16 v[80:95], v[104:107], v[24:27], v[80:95]
    s_waitcnt lgkmcnt(4)
    v_mfma_f32_32x32x16_bf16 v[80:95], v[108:111], v[28:31], v[80:95]
    s_waitcnt lgkmcnt(3)
    v_mfma_f32_32x32x16_bf16 v[80:95], v[112:115], v[32:35], v[80:95]
    s_waitcnt lgkmcnt(2)
    v_mfma_f32_32x32x16_bf16 v[80:95], v[116:119], v[36:39], v[80:95]
    s_waitcnt lgkmcnt(1)
    v_mfma_f32_32x32x16_bf16 v[80:95], v[120:123], v[40:43], v[80:95]
    s_waitcnt lgkmcnt(0)
    v_mfma_f32_32x32x16_bf16 v[80:95], v[124:127], v[44:47], v[80:95]
    v_mov_b32 v10, 156340
    ds_read_b32 v11, v10
    s_waitcnt lgkmcnt(0)
    v_cmp_gt_u32 vcc, 1, v11
    s_cbranch_vccnz Lst_75
Lrt_76:
    ds_read_b32 v11, v10 offset:44
    s_waitcnt lgkmcnt(0)
    v_readfirstlane_b32 s44, v11
    ds_read_b32 v3, v6
    s_waitcnt lgkmcnt(0)
    v_cmp_gt_u32 vcc, 1, v3
    s_cbranch_vccnz Lst_78
Lrt_79:
    ds_read_b128 v[128:131], v9 offset:0
    ds_read_b128 v[132:135], v9 offset:32
    ds_read_b128 v[136:139], v9 offset:64
    ds_read_b128 v[140:143], v9 offset:96
    ds_read_b128 v[144:147], v9 offset:128
    ds_read_b128 v[148:151], v9 offset:160
    ds_read_b128 v[152:155], v9 offset:192
    ds_read_b128 v[156:159], v9 offset:224
    ds_read_b128 v[160:163], v14
    v_fmac_f32 v64, v164, v80
    v_fmac_f32 v65, v164, v81
    v_fmac_f32 v66, v164, v82
    v_fmac_f32 v67, v164, v83
    v_fmac_f32 v68, v164, v84
    v_fmac_f32 v69, v164, v85
    v_fmac_f32 v70, v164, v86
    v_fmac_f32 v71, v164, v87
    v_fmac_f32 v72, v164, v88
    v_fmac_f32 v73, v164, v89
    v_fmac_f32 v74, v164, v90
    v_fmac_f32 v75, v164, v91
    v_fmac_f32 v76, v164, v92
    v_fmac_f32 v77, v164, v93
    v_fmac_f32 v78, v164, v94
    v_fmac_f32 v79, v164, v95
    v_fmac_f32_dpp v64, v80, v165 quad_perm:[1,0,3,2] row_mask:0xf bank_mask:0xf
    v_fmac_f32_dpp v65, v81, v165 quad_perm:[1,0,3,2] row_mask:0xf bank_mask:0xf
    v_fmac_f32_dpp v66, v82, v165 quad_perm:[1,0,3,2] row_mask:0xf bank_mask:0xf
    v_fmac_f32_dpp v67, v83, v165 quad_perm:[1,0,3,2] row_mask:0xf bank_mask:0xf
    v_fmac_f32_dpp v68, v84, v165 quad_perm:[1,0,3,2] row_mask:0xf bank_mask:0xf
    v_fmac_f32_dpp v69, v85, v165 quad_perm:[1,0,3,2] row_mask:0xf bank_mask:0xf
    v_fmac_f32_dpp v70, v86, v165 quad_perm:[1,0,3,2] row_mask:0xf bank_mask:0xf
    v_fmac_f32_dpp v71, v87, v165 quad_perm:[1,0,3,2] row_mask:0xf bank_mask:0xf
    v_fmac_f32_dpp v72, v88, v165 quad_perm:[1,0,3,2] row_mask:0xf bank_mask:0xf
    v_fmac_f32_dpp v73, v89, v165 quad_perm:[1,0,3,2] row_mask:0xf bank_mask:0xf
    v_fmac_f32_dpp v74, v90, v165 quad_perm:[1,0,3,2] row_mask:0xf bank_mask:0xf
    v_fmac_f32_dpp v75, v91, v165 quad_perm:[1,0,3,2] row_mask:0xf bank_mask:0xf
    v_fmac_f32_dpp v76, v92, v165 quad_perm:[1,0,3,2] row_mask:0xf bank_mask:0xf
    v_fmac_f32_dpp v77, v93, v165 quad_perm:[1,0,3,2] row_mask:0xf bank_mask:0xf
    v_fmac_f32_dpp v78, v94, v165 quad_perm:[1,0,3,2] row_mask:0xf bank_mask:0xf
    v_fmac_f32_dpp v79, v95, v165 quad_perm:[1,0,3,2] row_mask:0xf bank_mask:0xf
    s_waitcnt lgkmcnt(8)
    v_mul_f32 v64, v64, v128
    v_mul_f32 v65, v65, v129
    v_mul_f32 v66, v66, v130
    v_mul_f32 v67, v67, v131
    s_waitcnt lgkmcnt(7)
    v_mul_f32 v68, v68, v132
    v_mul_f32 v69, v69, v133
    v_mul_f32 v70, v70, v134
    v_mul_f32 v71, v71, v135
    s_waitcnt lgkmcnt(6)
    v_mul_f32 v72, v72, v136
    v_mul_f32 v73, v73, v137
    v_mul_f32 v74, v74, v138
    v_mul_f32 v75, v75, v139
    s_waitcnt lgkmcnt(5)
    v_mul_f32 v76, v76, v140
    v_mul_f32 v77, v77, v141
    v_mul_f32 v78, v78, v142
    v_mul_f32 v79, v79, v143
    s_waitcnt lgkmcnt(4)
    v_fmac_f32 v64, v167, v144
    v_fmac_f32 v65, v167, v145
    v_fmac_f32 v66, v167, v146
    v_fmac_f32 v67, v167, v147
    s_waitcnt lgkmcnt(3)
    v_fmac_f32 v68, v167, v148
    v_fmac_f32 v69, v167, v149
    v_fmac_f32 v70, v167, v150
    v_fmac_f32 v71, v167, v151
    s_waitcnt lgkmcnt(2)
    v_fmac_f32 v72, v167, v152
    v_fmac_f32 v73, v167, v153
    v_fmac_f32 v74, v167, v154
    v_fmac_f32 v75, v167, v155
    s_waitcnt lgkmcnt(1)
    v_fmac_f32 v76, v167, v156
    v_fmac_f32 v77, v167, v157
    v_fmac_f32 v78, v167, v158
    v_fmac_f32 v79, v167, v159
    v_cvt_pk_bf16_f32 v96, v64, v65
    v_cvt_pk_bf16_f32 v97, v66, v67
    v_cvt_pk_bf16_f32 v98, v68, v69
    v_cvt_pk_bf16_f32 v99, v70, v71
    v_cvt_pk_bf16_f32 v100, v72, v73
    v_cvt_pk_bf16_f32 v101, v74, v75
    v_cvt_pk_bf16_f32 v102, v76, v77
    v_cvt_pk_bf16_f32 v103, v78, v79
    v_xor_b32_dpp v104, v96, v4 quad_perm:[1,0,3,2] row_mask:0xf bank_mask:0xf
    v_xor_b32_dpp v105, v97, v4 quad_perm:[1,0,3,2] row_mask:0xf bank_mask:0xf
    v_xor_b32_dpp v106, v98, v4 quad_perm:[1,0,3,2] row_mask:0xf bank_mask:0xf
    v_xor_b32_dpp v107, v99, v4 quad_perm:[1,0,3,2] row_mask:0xf bank_mask:0xf
    v_xor_b32_dpp v108, v100, v4 quad_perm:[1,0,3,2] row_mask:0xf bank_mask:0xf
    v_xor_b32_dpp v109, v101, v4 quad_perm:[1,0,3,2] row_mask:0xf bank_mask:0xf
    v_xor_b32_dpp v110, v102, v4 quad_perm:[1,0,3,2] row_mask:0xf bank_mask:0xf
    v_xor_b32_dpp v111, v103, v4 quad_perm:[1,0,3,2] row_mask:0xf bank_mask:0xf
    v_mfma_f32_32x32x16_bf16 v[80:95], v[96:99], v[48:51], 0
    v_mfma_f32_32x32x16_bf16 v[80:95], v[100:103], v[52:55], v[80:95]
    v_mfma_f32_32x32x16_bf16 v[80:95], v[104:107], v[56:59], v[80:95]
    v_mfma_f32_32x32x16_bf16 v[80:95], v[108:111], v[60:63], v[80:95]
    v_mov_b32 v3, 1
    ds_write_b32 v1, v3 offset:144
    s_mov_b64 exec, 0xff
    s_waitcnt lgkmcnt(1)
    buffer_store_dwordx4 v[160:163], v12, s[20:23], s54 offen sc1
    s_mov_b64 exec, -1
    s_mov_b32 s59, s44
    ds_read_b32 v3, v7
    s_nop 3
    v_cvt_pk_bf16_f32 v112, v80, v81
    s_add_u32 s48, s53, 0
    buffer_store_dword v112, v13, s[20:23], s48 offen sc1
    v_cvt_pk_bf16_f32 v113, v82, v83
    s_add_u32 s48, s53, 8192
    buffer_store_dword v113, v13, s[20:23], s48 offen sc1
    v_cvt_pk_bf16_f32 v114, v84, v85
    s_add_u32 s48, s53, 32768
    buffer_store_dword v114, v13, s[20:23], s48 offen sc1
    v_cvt_pk_bf16_f32 v115, v86, v87
    s_add_u32 s48, s53, 40960
    buffer_store_dword v115, v13, s[20:23], s48 offen sc1
    v_cvt_pk_bf16_f32 v116, v88, v89
    s_add_u32 s48, s53, 65536
    buffer_store_dword v116, v13, s[20:23], s48 offen sc1
    v_cvt_pk_bf16_f32 v117, v90, v91
    s_add_u32 s48, s53, 73728
    buffer_store_dword v117, v13, s[20:23], s48 offen sc1
    v_cvt_pk_bf16_f32 v118, v92, v93
    s_add_u32 s48, s53, 98304
    buffer_store_dword v118, v13, s[20:23], s48 offen sc1
    v_cvt_pk_bf16_f32 v119, v94, v95
    s_add_u32 s48, s53, 106496
    buffer_store_dword v119, v13, s[20:23], s48 offen sc1
    s_waitcnt lgkmcnt(0)
    v_cmp_gt_u32 vcc, 1, v3
    s_cbranch_vccnz Lst_81
Lrt_82:
    s_waitcnt vmcnt(0)
    s_atomic_add s55, s[60:61], 0 glc
    s_atomic_add s56, s[60:61], 256 glc
    s_atomic_add s57, s[60:61], 512 glc
    s_atomic_add s58, s[60:61], 768 glc
    s_cmp_lg_u32 s51, 0
    s_cbranch_scc1 Lcs_84
    s_mov_b32 s59, 1
    s_atomic_add s59, s[62:63], 0 glc
Lcs_84:
    v_mov_b32 v3, 1
    ds_write_b32 v1, v3 offset:112
    s_setprio 1
    s_xor_b32 s50, s2, 0xff
    v_bfe_u32 v10, v0, 1, 4
    s_lshl_b32 s47, s41, 4
    v_add_u32 v10, s47, v10
    v_cvt_f32_u32 v10, v10
    v_and_b32 v11, 1, v0
    v_cvt_f32_u32 v11, v11
    v_lshrrev_b32 v12, 5, v0
    v_cvt_f32_u32 v12, v12
    v_mul_f32 v8, 0x3c800000, v10
    v_add_f32 v13, v12, v12
    v_mul_f32 v9, v13, v8
    v_fmamk_f32 v9, v11, 0x3e800000, v9
    v_mov_b32 v152, v9
    v_cos_f32 v153, v152
    v_sin_f32 v154, v152
    v_fmamk_f32 v155, v8, 0x3f800000, v9
    v_cos_f32 v156, v155
    v_sin_f32 v157, v155
    v_cvt_pk_bf16_f32 v16, v153, v154
    v_fmamk_f32 v152, v8, 0x40800000, v9
    v_cos_f32 v153, v152
    v_sin_f32 v154, v152
    v_cvt_pk_bf16_f32 v17, v156, v157
    v_fmamk_f32 v155, v8, 0x40a00000, v9
    v_cos_f32 v156, v155
    v_sin_f32 v157, v155
    v_cvt_pk_bf16_f32 v18, v153, v154
    v_fmamk_f32 v152, v8, 0x41000000, v9
    v_cos_f32 v153, v152
    v_sin_f32 v154, v152
    v_cvt_pk_bf16_f32 v19, v156, v157
    v_fmamk_f32 v155, v8, 0x41100000, v9
    v_cos_f32 v156, v155
    v_sin_f32 v157, v155
    v_cvt_pk_bf16_f32 v20, v153, v154
    v_fmamk_f32 v152, v8, 0x41400000, v9
    v_cos_f32 v153, v152
    v_sin_f32 v154, v152
    v_cvt_pk_bf16_f32 v21, v156, v157
    v_fmamk_f32 v155, v8, 0x41500000, v9
    v_cos_f32 v156, v155
    v_sin_f32 v157, v155
    v_cvt_pk_bf16_f32 v22, v153, v154
    v_cvt_pk_bf16_f32 v23, v156, v157
    v_lshrrev_b32 v13, 1, v0
    v_and_b32 v152, 1, v13
    v_lshlrev_b32 v152, 4, v152
    v_bfe_u32 v154, v13, 1, 1
    v_lshlrev_b32 v153, 31, v154
    v_xor_b32 v154, v154, v13
    v_and_b32 v154, 1, v154
    v_lshl_or_b32 v153, v154, 15, v153
    s_mov_b32 s47, 0x80008000
    v_and_b32 v13, 1, v13
    v_mul_lo_u32 v154, v13, s47
    v_alignbit_b32 v24, v16, v16, v152
    v_alignbit_b32 v25, v17, v17, v152
    v_alignbit_b32 v26, v18, v18, v152
    v_alignbit_b32 v27, v19, v19, v152
    v_alignbit_b32 v28, v20, v20, v152
    v_alignbit_b32 v29, v21, v21, v152
    v_alignbit_b32 v30, v22, v22, v152
    v_alignbit_b32 v31, v23, v23, v152
    v_xor_b32 v24, v153, v24
    v_xor_b32 v25, v153, v25
    v_xor_b32 v26, v153, v26
    v_xor_b32 v27, v153, v27
    v_xor_b32 v28, v153, v28
    v_xor_b32 v29, v153, v29
    v_xor_b32 v30, v153, v30
    v_xor_b32 v31, v153, v31
    v_xor_b32 v32, v154, v16
    v_xor_b32 v33, v154, v17
    v_xor_b32 v34, v154, v18
    v_xor_b32 v35, v154, v19
    v_xor_b32 v36, v154, v20
    v_xor_b32 v37, v154, v21
    v_xor_b32 v38, v154, v22
    v_xor_b32 v39, v154, v23
    v_xor_b32 v40, v154, v24
    v_xor_b32 v41, v154, v25
    v_xor_b32 v42, v154, v26
    v_xor_b32 v43, v154, v27
    v_xor_b32 v44, v154, v28
    v_xor_b32 v45, v154, v29
    v_xor_b32 v46, v154, v30
    v_xor_b32 v47, v154, v31
    v_fma_f32 v13, v11, -2.0, 1.0
    v_mul_f32 v8, v13, v10
    v_mul_f32 v8, 0x3a000000, v8
    v_mul_f32 v13, 4.0, v12
    v_mul_f32 v9, v13, v8
    v_mov_b32 v152, v9
    v_cos_f32 v48, v152
    v_sin_f32 v64, v152
    v_fmamk_f32 v153, v8, 0x3f800000, v9
    v_cos_f32 v49, v153
    v_sin_f32 v65, v153
    v_fmamk_f32 v152, v8, 0x40000000, v9
    v_cos_f32 v50, v152
    v_sin_f32 v66, v152
    v_fmamk_f32 v153, v8, 0x40400000, v9
    v_cos_f32 v51, v153
    v_sin_f32 v67, v153
    v_fmamk_f32 v152, v8, 0x41000000, v9
    v_cos_f32 v52, v152
    v_sin_f32 v68, v152
    v_fmamk_f32 v153, v8, 0x41100000, v9
    v_cos_f32 v53, v153
    v_sin_f32 v69, v153
    v_fmamk_f32 v152, v8, 0x41200000, v9
    v_cos_f32 v54, v152
    v_sin_f32 v70, v152
    v_fmamk_f32 v153, v8, 0x41300000, v9
    v_cos_f32 v55, v153
    v_sin_f32 v71, v153
    v_fmamk_f32 v152, v8, 0x41800000, v9
    v_cos_f32 v56, v152
    v_sin_f32 v72, v152
    v_fmamk_f32 v153, v8, 0x41880000, v9
    v_cos_f32 v57, v153
    v_sin_f32 v73, v153
    v_fmamk_f32 v152, v8, 0x41900000, v9
    v_cos_f32 v58, v152
    v_sin_f32 v74, v152
    v_fmamk_f32 v153, v8, 0x41980000, v9
    v_cos_f32 v59, v153
    v_sin_f32 v75, v153
    v_fmamk_f32 v152, v8, 0x41c00000, v9
    v_cos_f32 v60, v152
    v_sin_f32 v76, v152
    v_fmamk_f32 v153, v8, 0x41c80000, v9
    v_cos_f32 v61, v153
    v_sin_f32 v77, v153
    v_fmamk_f32 v152, v8, 0x41d00000, v9
    v_cos_f32 v62, v152
    v_sin_f32 v78, v152
    v_fmamk_f32 v153, v8, 0x41d80000, v9
    v_cos_f32 v63, v153
    v_sin_f32 v79, v153
    v_and_b32 v10, 31, v0
    v_cvt_f32_u32 v10, v10
    v_mul_f32 v8, 0x3d000000, v10
    v_mul_f32 v9, v13, v8
    v_mov_b32 v152, v9
    v_cos_f32 v153, v152
    v_sin_f32 v154, v152
    v_fmamk_f32 v155, v8, 0x3f800000, v9
    v_cos_f32 v156, v155
    v_sin_f32 v157, v155
    v_cvt_pk_bf16_f32 v80, v153, v156
    v_cvt_pk_bf16_f32 v88, v154, v157
    v_fmamk_f32 v152, v8, 0x40000000, v9
    v_cos_f32 v153, v152
    v_sin_f32 v154, v152
    v_fmamk_f32 v155, v8, 0x40400000, v9
    v_cos_f32 v156, v155
    v_sin_f32 v157, v155
    v_cvt_pk_bf16_f32 v81, v153, v156
    v_cvt_pk_bf16_f32 v89, v154, v157
    s_mov_b32 s47, 0x80008000
    v_bfe_u32 v152, v0, 1, 1
    v_mul_lo_u32 v152, v152, s47
    v_xor_b32 v153, v152, v4
    s_mov_b32 vcc_lo, 0xaaaaaaaa
    s_mov_b32 vcc_hi, 0xaaaaaaaa
    v_cndmask_b32 v82, v80, v88, vcc
    v_cndmask_b32 v90, v88, v80, vcc
    v_cndmask_b32 v83, v81, v89, vcc
    v_cndmask_b32 v91, v89, v81, vcc
    v_xor_b32 v82, v153, v82
    v_xor_b32 v90, v152, v90
    v_xor_b32 v83, v153, v83
    v_xor_b32 v91, v152, v91
    v_xor_b32 v84, v4, v80
    v_xor_b32 v92, v4, v88
    v_xor_b32 v85, v4, v81
    v_xor_b32 v93, v4, v89
    v_xor_b32 v86, v4, v82
    v_xor_b32 v94, v4, v90
    v_xor_b32 v87, v4, v83
    v_xor_b32 v95, v4, v91
    v_and_b32 v5, 31, v0
    v_lshlrev_b32 v5, 2, v5
    v_lshrrev_b32 v10, 5, v0
    v_lshl_add_u32 v5, v10, 8, v5
    v_lshlrev_b32 v6, 4, v0
    s_mul_i32 s51, s50, 8192
    s_lshl_b32 s47, s41, 11
    s_add_u32 s51, s51, s47
    s_add_u32 s52, s51, 6291456
    s_add_u32 s53, s51, 11534336
    s_add_u32 s54, s51, 8912896
    s_add_u32 s47, s47, 122976
    v_add_u32 v7, s47, v6
    v_add_u32 v8, 122976, v6
    v_add_u32 v14, s47, v5
    v_and_b32 v13, 7, v0
    v_lshlrev_b32 v13, 6, v13
    v_bfe_u32 v10, v0, 4, 1
    v_lshl_add_u32 v13, v10, 9, v13
    v_bfe_u32 v10, v0, 3, 1
    v_lshl_add_u32 v13, v10, 2, v13
    v_lshrrev_b32 v10, 5, v0
    v_lshl_add_u32 v13, v10, 3, v13
    v_add_u32 v13, s47, v13
    v_mov_b32 v9, 156344
    s_waitcnt lgkmcnt(0)
    s_sub_u32 s55, s55, s44
    s_cmp_ge_u32 s55, 64
    s_cbranch_scc1 Las_85
Lar_86:
    s_sub_u32 s56, s56, s44
    s_cmp_ge_u32 s56, 64
    s_cbranch_scc1 Las_88
Lar_89:
    s_sub_u32 s57, s57, s44
    s_cmp_ge_u32 s57, 64
    s_cbranch_scc1 Las_91
Lar_92:
    s_sub_u32 s58, s58, s44
    s_cmp_ge_u32 s58, 64
    s_cbranch_scc1 Las_94
Lar_95:
    s_sub_u32 s59, s59, s44
    s_cmp_ge_u32 s59, 64
    s_cbranch_scc1 Las_97
Lar_98:
    s_setprio 3
    ds_read_b32 v3, v9
    s_waitcnt lgkmcnt(0)
    v_cmp_gt_u32 vcc, 1, v3
    s_cbranch_vccnz Lst_100
Lrt_101:
    buffer_load_dword v96, v5, s[20:23], s52 offen offset:0 sc1
    buffer_load_dword v97, v5, s[20:23], s52 offen offset:128 sc1
    buffer_load_dword v98, v5, s[20:23], s52 offen offset:512 sc1
    buffer_load_dword v99, v5, s[20:23], s52 offen offset:640 sc1
    buffer_load_dword v100, v5, s[20:23], s52 offen offset:1024 sc1
    buffer_load_dword v101, v5, s[20:23], s52 offen offset:1152 sc1
    buffer_load_dword v102, v5, s[20:23], s52 offen offset:1536 sc1
    buffer_load_dword v103, v5, s[20:23], s52 offen offset:1664 sc1
    buffer_load_dwordx4 v[144:147], v6, s[20:23], s53 offen sc1
    buffer_load_dwordx4 v[148:151], v6, s[20:23], s53 offen offset:1024 sc1
    s_cmp_lg_u32 s50, 0
    s_cbranch_scc1 Lx256_103
    s_add_u32 s47, s53, 2097152
    buffer_load_dwordx4 v[152:155], v6, s[20:23], s47 offen sc1
    buffer_load_dwordx4 v[156:159], v6, s[20:23], s47 offen offset:1024 sc1
Lx256_103:
    s_waitcnt vmcnt(6)
    ds_write_b128 v7, v[96:99]
    s_waitcnt vmcnt(2)
    ds_write_b128 v7, v[100:103] offset:1024
    v_mov_b32 v3, 2
    ds_write_b32 v1, v3
    ds_read_b32 v3, v2
    s_waitcnt lgkmcnt(0)
    v_cmp_gt_u32 vcc, 2, v3
    s_cbranch_vccnz Lst_104
Lrt_105:
    ds_read_b128 v[96:99], v8 offset:0
    ds_read_b128 v[100:103], v8 offset:1024
    ds_read_b128 v[104:107], v8 offset:2048
    ds_read_b128 v[108:111], v8 offset:3072
    ds_read_b128 v[112:115], v8 offset:4096
    ds_read_b128 v[116:119], v8 offset:5120
    ds_read_b128 v[120:123], v8 offset:6144
    ds_read_b128 v[124:127], v8 offset:7168
    s_waitcnt lgkmcnt(7)
    v_mfma_f32_32x32x16_bf16 v[128:143], v[16:19], v[96:99], 0
    s_waitcnt lgkmcnt(6)
    v_mfma_f32_32x32x16_bf16 v[128:143], v[20:23], v[100:103], v[128:143]
    s_waitcnt lgkmcnt(5)
    v_mfma_f32_32x32x16_bf16 v[128:143], v[24:27], v[104:107], v[128:143]
    s_waitcnt lgkmcnt(4)
    v_mfma_f32_32x32x16_bf16 v[128:143], v[28:31], v[108:111], v[128:143]
    s_waitcnt lgkmcnt(3)
    v_mfma_f32_32x32x16_bf16 v[128:143], v[32:35], v[112:115], v[128:143]
    s_waitcnt lgkmcnt(2)
    v_mfma_f32_32x32x16_bf16 v[128:143], v[36:39], v[116:119], v[128:143]
    s_waitcnt lgkmcnt(1)
    v_mfma_f32_32x32x16_bf16 v[128:143], v[40:43], v[120:123], v[128:143]
    s_waitcnt lgkmcnt(0)
    v_mfma_f32_32x32x16_bf16 v[128:143], v[44:47], v[124:127], v[128:143]
    s_waitcnt vmcnt(0)
    s_cmp_eq_u32 s50, 0
    s_cbranch_scc1 Lp2s_107
    v_lshlrev_b32 v96, 16, v144
    v_lshlrev_b32 v97, 16, v148
    v_and_b32 v98, 0xffff0000, v144
    v_and_b32 v99, 0xffff0000, v148
    v_lshlrev_b32 v100, 16, v145
    v_lshlrev_b32 v101, 16, v149
    v_and_b32 v102, 0xffff0000, v145
    v_and_b32 v103, 0xffff0000, v149
    v_lshlrev_b32 v104, 16, v146
    v_lshlrev_b32 v105, 16, v150
    v_and_b32 v106, 0xffff0000, v146
    v_and_b32 v107, 0xffff0000, v150
    v_lshlrev_b32 v108, 16, v147
    v_lshlrev_b32 v109, 16, v151
    v_and_b32 v110, 0xffff0000, v147
    v_and_b32 v111, 0xffff0000, v151
    v_mul_f32 v112, v128, v96
    v_mul_f32 v113, v128, v97
    v_fma_f32 v112, -v129, v97, v112
    v_fmac_f32 v113, v129, v96
    v_mul_f32 v114, v130, v98
    v_mul_f32 v115, v130, v99
    v_fma_f32 v114, -v131, v99, v114
    v_fmac_f32 v115, v131, v98
    v_mul_f32 v116, v132, v100
    v_mul_f32 v117, v132, v101
    v_fma_f32 v116, -v133, v101, v116
    v_fmac_f32 v117, v133, v100
    v_mul_f32 v118, v134, v102
    v_mul_f32 v119, v134, v103
    v_fma_f32 v118, -v135, v103, v118
    v_fmac_f32 v119, v135, v102
    v_mul_f32 v120, v136, v104
    v_mul_f32 v121, v136, v105
    v_fma_f32 v120, -v137, v105, v120
    v_fmac_f32 v121, v137, v104
    v_mul_f32 v122, v138, v106
    v_mul_f32 v123, v138, v107
    v_fma_f32 v122, -v139, v107, v122
    v_fmac_f32 v123, v139, v106
    v_mul_f32 v124, v140, v108
    v_mul_f32 v125, v140, v109
    v_fma_f32 v124, -v141, v109, v124
    v_fmac_f32 v125, v141, v108
    v_mul_f32 v126, v142, v110
    v_mul_f32 v127, v142, v111
    v_fma_f32 v126, -v143, v111, v126
    v_fmac_f32 v127, v143, v110
Lp2b_108:
    v_cvt_pk_bf16_f32 v152, v112, -v113
    v_cvt_pk_bf16_f32 v153, v114, -v115
    v_cvt_pk_bf16_f32 v154, v116, -v117
    v_cvt_pk_bf16_f32 v155, v118, -v119
    v_cvt_pk_bf16_f32 v156, v120, -v121
    v_cvt_pk_bf16_f32 v157, v122, -v123
    v_cvt_pk_bf16_f32 v158, v124, -v125
    v_cvt_pk_bf16_f32 v159, v126, -v127
    ds_write_b128 v7, v[152:155] offset:8192
    ds_write_b128 v7, v[156:159] offset:9216
    v_mov_b32 v3, 4
    ds_write_b32 v1, v3
    ds_read_b32 v3, v2
    s_waitcnt lgkmcnt(0)
    v_cmp_gt_u32 vcc, 4, v3
    s_cbranch_vccnz Lst_109
Lrt_110:
    ds_read_b128 v[96:99], v8 offset:8192
    ds_read_b128 v[100:103], v8 offset:9216
    ds_read_b128 v[104:107], v8 offset:10240
    ds_read_b128 v[108:111], v8 offset:11264
    ds_read_b128 v[112:115], v8 offset:12288
    ds_read_b128 v[116:119], v8 offset:13312
    ds_read_b128 v[120:123], v8 offset:14336
    ds_read_b128 v[124:127], v8 offset:15360
    s_waitcnt lgkmcnt(7)
    v_mfma_f32_32x32x16_bf16 v[128:143], v[96:99], v[16:19], 0
    s_waitcnt lgkmcnt(6)
    v_mfma_f32_32x32x16_bf16 v[128:143], v[100:103], v[20:23], v[128:143]
    s_waitcnt lgkmcnt(5)
    v_mfma_f32_32x32x16_bf16 v[128:143], v[104:107], v[24:27], v[128:143]
    s_waitcnt lgkmcnt(4)
    v_mfma_f32_32x32x16_bf16 v[128:143], v[108:111], v[28:31], v[128:143]
    s_waitcnt lgkmcnt(3)
    v_mfma_f32_32x32x16_bf16 v[128:143], v[112:115], v[32:35], v[128:143]
    s_waitcnt lgkmcnt(2)
    v_mfma_f32_32x32x16_bf16 v[128:143], v[116:119], v[36:39], v[128:143]
    s_waitcnt lgkmcnt(1)
    v_mfma_f32_32x32x16_bf16 v[128:143], v[120:123], v[40:43], v[128:143]
    s_waitcnt lgkmcnt(0)
    v_mfma_f32_32x32x16_bf16 v[128:143], v[124:127], v[44:47], v[128:143]
    s_nop 11
    v_mul_f32 v48, v128, v48
    v_mul_f32 v49, v129, v49
    v_mul_f32 v50, v130, v50
    v_mul_f32 v51, v131, v51
    v_mul_f32 v52, v132, v52
    v_mul_f32 v53, v133, v53
    v_mul_f32 v54, v134, v54
    v_mul_f32 v55, v135, v55
    v_mul_f32 v56, v136, v56
    v_mul_f32 v57, v137, v57
    v_mul_f32 v58, v138, v58
    v_mul_f32 v59, v139, v59
    v_mul_f32 v60, v140, v60
    v_mul_f32 v61, v141, v61
    v_mul_f32 v62, v142, v62
    v_mul_f32 v63, v143, v63
    v_fmac_f32_dpp v48, v128, v64 quad_perm:[1,0,3,2] row_mask:0xf bank_mask:0xf
    v_fmac_f32_dpp v49, v129, v65 quad_perm:[1,0,3,2] row_mask:0xf bank_mask:0xf
    v_fmac_f32_dpp v50, v130, v66 quad_perm:[1,0,3,2] row_mask:0xf bank_mask:0xf
    v_fmac_f32_dpp v51, v131, v67 quad_perm:[1,0,3,2] row_mask:0xf bank_mask:0xf
    v_fmac_f32_dpp v52, v132, v68 quad_perm:[1,0,3,2] row_mask:0xf bank_mask:0xf
    v_fmac_f32_dpp v53, v133, v69 quad_perm:[1,0,3,2] row_mask:0xf bank_mask:0xf
    v_fmac_f32_dpp v54, v134, v70 quad_perm:[1,0,3,2] row_mask:0xf bank_mask:0xf
    v_fmac_f32_dpp v55, v135, v71 quad_perm:[1,0,3,2] row_mask:0xf bank_mask:0xf
    v_fmac_f32_dpp v56, v136, v72 quad_perm:[1,0,3,2] row_mask:0xf bank_mask:0xf
    v_fmac_f32_dpp v57, v137, v73 quad_perm:[1,0,3,2] row_mask:0xf bank_mask:0xf
    v_fmac_f32_dpp v58, v138, v74 quad_perm:[1,0,3,2] row_mask:0xf bank_mask:0xf
    v_fmac_f32_dpp v59, v139, v75 quad_perm:[1,0,3,2] row_mask:0xf bank_mask:0xf
    v_fmac_f32_dpp v60, v140, v76 quad_perm:[1,0,3,2] row_mask:0xf bank_mask:0xf
    v_fmac_f32_dpp v61, v141, v77 quad_perm:[1,0,3,2] row_mask:0xf bank_mask:0xf
    v_fmac_f32_dpp v62, v142, v78 quad_perm:[1,0,3,2] row_mask:0xf bank_mask:0xf
    v_fmac_f32_dpp v63, v143, v79 quad_perm:[1,0,3,2] row_mask:0xf bank_mask:0xf
    v_cvt_pk_bf16_f32 v96, v48, v49
    v_cvt_pk_bf16_f32 v97, v50, v51
    v_cvt_pk_bf16_f32 v98, v52, v53
    v_cvt_pk_bf16_f32 v99, v54, v55
    v_cvt_pk_bf16_f32 v100, v56, v57
    v_cvt_pk_bf16_f32 v101, v58, v59
    v_cvt_pk_bf16_f32 v102, v60, v61
    v_cvt_pk_bf16_f32 v103, v62, v63
    v_xor_b32_dpp v104, v96, v4 quad_perm:[1,0,3,2] row_mask:0xf bank_mask:0xf
    v_xor_b32_dpp v105, v97, v4 quad_perm:[1,0,3,2] row_mask:0xf bank_mask:0xf
    v_xor_b32_dpp v106, v98, v4 quad_perm:[1,0,3,2] row_mask:0xf bank_mask:0xf
    v_xor_b32_dpp v107, v99, v4 quad_perm:[1,0,3,2] row_mask:0xf bank_mask:0xf
    v_xor_b32_dpp v108, v100, v4 quad_perm:[1,0,3,2] row_mask:0xf bank_mask:0xf
    v_xor_b32_dpp v109, v101, v4 quad_perm:[1,0,3,2] row_mask:0xf bank_mask:0xf
    v_xor_b32_dpp v110, v102, v4 quad_perm:[1,0,3,2] row_mask:0xf bank_mask:0xf
    v_xor_b32_dpp v111, v103, v4 quad_perm:[1,0,3,2] row_mask:0xf bank_mask:0xf
    v_mfma_f32_32x32x16_bf16 v[128:143], v[96:99], v[80:83], 0
    v_mfma_f32_32x32x16_bf16 v[128:143], v[100:103], v[84:87], v[128:143]
    v_mfma_f32_32x32x16_bf16 v[128:143], v[104:107], v[88:91], v[128:143]
    v_mfma_f32_32x32x16_bf16 v[128:143], v[108:111], v[92:95], v[128:143]
    s_lshr_b32 s47, s50, 5
    s_lshl_b32 s48, s41, 3
    s_add_u32 s47, s47, s48
    s_lshl_b32 s47, s47, 12
    s_add_u32 s60, s47, 14811136
    s_add_u32 s60, s82, s60
    s_addc_u32 s61, s83, 0
    s_mov_b32 s55, 1
    s_nop 3
    v_cvt_pk_bf16_f32 v152, v128, v129
    buffer_store_dword v152, v5, s[20:23], s54 offen offset:0 sc1
    v_cvt_pk_bf16_f32 v153, v130, v131
    buffer_store_dword v153, v5, s[20:23], s54 offen offset:128 sc1
    v_cvt_pk_bf16_f32 v154, v132, v133
    buffer_store_dword v154, v5, s[20:23], s54 offen offset:512 sc1
    v_cvt_pk_bf16_f32 v155, v134, v135
    buffer_store_dword v155, v5, s[20:23], s54 offen offset:640 sc1
    v_cvt_pk_bf16_f32 v156, v136, v137
    buffer_store_dword v156, v5, s[20:23], s54 offen offset:1024 sc1
    v_cvt_pk_bf16_f32 v157, v138, v139
    buffer_store_dword v157, v5, s[20:23], s54 offen offset:1152 sc1
    v_cvt_pk_bf16_f32 v158, v140, v141
    buffer_store_dword v158, v5, s[20:23], s54 offen offset:1536 sc1
    v_cvt_pk_bf16_f32 v159, v142, v143
    buffer_store_dword v159, v5, s[20:23], s54 offen offset:1664 sc1
    s_setprio 1
    s_waitcnt vmcnt(0)
    s_atomic_add s55, s[60:61], 0
    s_atomic_add s55, s[60:61], 256
    s_atomic_add s55, s[60:61], 512
    s_atomic_add s55, s[60:61], 768
    s_atomic_add s55, s[60:61], 1024
    s_atomic_add s55, s[60:61], 1280
    s_atomic_add s55, s[60:61], 1536
    s_atomic_add s55, s[60:61], 1792
    s_atomic_add s55, s[60:61], 2048
    s_atomic_add s55, s[60:61], 2304
    s_atomic_add s55, s[60:61], 2560
    s_atomic_add s55, s[60:61], 2816
    s_atomic_add s55, s[60:61], 3072
    s_atomic_add s55, s[60:61], 3328
    s_atomic_add s55, s[60:61], 3584
    s_atomic_add s55, s[60:61], 3840
    v_mov_b32 v3, 2
    ds_write_b32 v1, v3 offset:112
    s_and_b32 s47, s43, 3
    s_lshl2_add_u32 s50, s42, s47
    s_lshr_b32 s51, s43, 2
    s_lshr_b32 s52, s41, 1
    s_and_b32 s53, s41, 1
    v_bfe_u32 v138, v0, 2, 1
    v_bfe_u32 v139, v0, 3, 2
    v_and_b32 v140, 3, v0
    v_lshl_add_u32 v140, v139, 2, v140
    v_lshl_add_u32 v140, v138, 4, v140
    v_lshrrev_b32 v141, 5, v0
    v_lshlrev_b32 v141, 2, v141
    s_lshl_b32 s47, s41, 4
    v_add_u32 v141, s47, v141
    v_cmp_eq_u32 s[56:57], 0, v141
    v_cvt_f32_u32 v142, v141
    v_and_b32 v143, 1, v0
    v_lshlrev_b32 v143, 31, v143
    v_xor_b32 v143, 0xbf003f00, v143
    v_and_b32 v152, 1, v0
    v_lshlrev_b32 v152, 4, v152
    v_bfe_u32 v154, v0, 1, 1
    v_lshlrev_b32 v153, 31, v154
    v_xor_b32 v154, v154, v0
    v_and_b32 v154, 1, v154
    v_lshl_or_b32 v153, v154, 15, v153
    v_xor_b32 v154, 0x80000000, v4
    s_xor_b32 s47, s53, 0
    s_lshl1_add_u32 s47, s51, s47
    s_lshl_b32 s47, s47, 5
    v_add_u32 v144, s47, v140
    v_cvt_f32_u32 v144, v144
    v_mul_f32 v144, 0x3b000000, v144
    v_mul_f32 v145, v144, v142
    v_mov_b32 v146, v145
    v_cos_f32 v147, v146
    v_sin_f32 v148, v146
    v_fmamk_f32 v149, v144, 0x3f800000, v145
    v_cos_f32 v150, v149
    v_sin_f32 v151, v149
    v_cvt_pk_bf16_f32 v8, v147, v148
    v_fmamk_f32 v146, v144, 0x40000000, v145
    v_cos_f32 v147, v146
    v_sin_f32 v148, v146
    v_cvt_pk_bf16_f32 v9, v150, v151
    v_fmamk_f32 v149, v144, 0x40400000, v145
    v_cos_f32 v150, v149
    v_sin_f32 v151, v149
    v_cvt_pk_bf16_f32 v10, v147, v148
    v_fmamk_f32 v146, v144, 0x41000000, v145
    v_cos_f32 v147, v146
    v_sin_f32 v148, v146
    v_cvt_pk_bf16_f32 v11, v150, v151
    v_fmamk_f32 v149, v144, 0x41100000, v145
    v_cos_f32 v150, v149
    v_sin_f32 v151, v149
    v_cvt_pk_bf16_f32 v12, v147, v148
    v_fmamk_f32 v146, v144, 0x41200000, v145
    v_cos_f32 v147, v146
    v_sin_f32 v148, v146
    v_cvt_pk_bf16_f32 v13, v150, v151
    v_fmamk_f32 v149, v144, 0x41300000, v145
    v_cos_f32 v150, v149
    v_sin_f32 v151, v149
    v_cvt_pk_bf16_f32 v14, v147, v148
    v_cvt_pk_bf16_f32 v15, v150, v151
    v_alignbit_b32 v16, v8, v8, v152
    v_alignbit_b32 v17, v9, v9, v152
    v_alignbit_b32 v18, v10, v10, v152
    v_alignbit_b32 v19, v11, v11, v152
    v_alignbit_b32 v20, v12, v12, v152
    v_alignbit_b32 v21, v13, v13, v152
    v_alignbit_b32 v22, v14, v14, v152
    v_alignbit_b32 v23, v15, v15, v152
    v_xor_b32 v16, v153, v16
    v_xor_b32 v17, v153, v17
    v_xor_b32 v18, v153, v18
    v_xor_b32 v19, v153, v19
    v_xor_b32 v20, v153, v20
    v_xor_b32 v21, v153, v21
    v_xor_b32 v22, v153, v22
    v_xor_b32 v23, v153, v23
    v_xor_b32 v24, v154, v8
    v_xor_b32 v25, v154, v9
    v_xor_b32 v26, v154, v10
    v_xor_b32 v27, v154, v11
    v_xor_b32 v28, v154, v12
    v_xor_b32 v29, v154, v13
    v_xor_b32 v30, v154, v14
    v_xor_b32 v31, v154, v15
    v_xor_b32 v32, v154, v16
    v_xor_b32 v33, v154, v17
    v_xor_b32 v34, v154, v18
    v_xor_b32 v35, v154, v19
    v_xor_b32 v36, v154, v20
    v_xor_b32 v37, v154, v21
    v_xor_b32 v38, v154, v22
    v_xor_b32 v39, v154, v23
    v_mul_f32 v146, 0x42800000, v144
    v_cos_f32 v147, v146
    v_sin_f32 v148, v146
    s_nop 0
    v_cvt_pk_bf16_f32 v155, v147, v148
    v_alignbit_b32 v156, v155, v155, v152
    v_xor_b32 v156, v153, v156
    v_cndmask_b32 v8, v8, v143, s[56:57]
    v_cndmask_b32 v24, v24, v156, s[56:57]
    v_cndmask_b32 v32, v32, v155, s[56:57]
    s_xor_b32 s47, s53, 1
    s_lshl1_add_u32 s47, s51, s47
    s_lshl_b32 s47, s47, 5
    v_add_u32 v144, s47, v140
    v_cvt_f32_u32 v144, v144
    v_mul_f32 v144, 0x3b000000, v144
    v_mul_f32 v145, v144, v142
    v_mov_b32 v146, v145
    v_cos_f32 v147, v146
    v_sin_f32 v148, v146
    v_fmamk_f32 v149, v144, 0x3f800000, v145
    v_cos_f32 v150, v149
    v_sin_f32 v151, v149
    v_cvt_pk_bf16_f32 v40, v147, v148
    v_fmamk_f32 v146, v144, 0x40000000, v145
    v_cos_f32 v147, v146
    v_sin_f32 v148, v146
    v_cvt_pk_bf16_f32 v41, v150, v151
    v_fmamk_f32 v149, v144, 0x40400000, v145
    v_cos_f32 v150, v149
    v_sin_f32 v151, v149
    v_cvt_pk_bf16_f32 v42, v147, v148
    v_fmamk_f32 v146, v144, 0x41000000, v145
    v_cos_f32 v147, v146
    v_sin_f32 v148, v146
    v_cvt_pk_bf16_f32 v43, v150, v151
    v_fmamk_f32 v149, v144, 0x41100000, v145
    v_cos_f32 v150, v149
    v_sin_f32 v151, v149
    v_cvt_pk_bf16_f32 v44, v147, v148
    v_fmamk_f32 v146, v144, 0x41200000, v145
    v_cos_f32 v147, v146
    v_sin_f32 v148, v146
    v_cvt_pk_bf16_f32 v45, v150, v151
    v_fmamk_f32 v149, v144, 0x41300000, v145
    v_cos_f32 v150, v149
    v_sin_f32 v151, v149
    v_cvt_pk_bf16_f32 v46, v147, v148
    v_cvt_pk_bf16_f32 v47, v150, v151
    v_alignbit_b32 v48, v40, v40, v152
    v_alignbit_b32 v49, v41, v41, v152
    v_alignbit_b32 v50, v42, v42, v152
    v_alignbit_b32 v51, v43, v43, v152
    v_alignbit_b32 v52, v44, v44, v152
    v_alignbit_b32 v53, v45, v45, v152
    v_alignbit_b32 v54, v46, v46, v152
    v_alignbit_b32 v55, v47, v47, v152
    v_xor_b32 v48, v153, v48
    v_xor_b32 v49, v153, v49
    v_xor_b32 v50, v153, v50
    v_xor_b32 v51, v153, v51
    v_xor_b32 v52, v153, v52
    v_xor_b32 v53, v153, v53
    v_xor_b32 v54, v153, v54
    v_xor_b32 v55, v153, v55
    v_xor_b32 v56, v154, v40
    v_xor_b32 v57, v154, v41
    v_xor_b32 v58, v154, v42
    v_xor_b32 v59, v154, v43
    v_xor_b32 v60, v154, v44
    v_xor_b32 v61, v154, v45
    v_xor_b32 v62, v154, v46
    v_xor_b32 v63, v154, v47
    v_xor_b32 v64, v154, v48
    v_xor_b32 v65, v154, v49
    v_xor_b32 v66, v154, v50
    v_xor_b32 v67, v154, v51
    v_xor_b32 v68, v154, v52
    v_xor_b32 v69, v154, v53
    v_xor_b32 v70, v154, v54
    v_xor_b32 v71, v154, v55
    v_cndmask_b32 v40, v40, v143, s[56:57]
    v_cndmask_b32 v56, v56, v156, s[56:57]
    v_cndmask_b32 v64, v64, v155, s[56:57]
    v_and_b32 v136, 31, v0
    v_lshlrev_b32 v136, 2, v136
    v_mul_u32_u24 v5, 8192, v141
    v_add_u32 v5, v5, v136
    v_sub_u32 v137, 64, v141
    v_mul_u32_u24 v6, 8192, v137
    v_add_u32 v6, v6, v136
    v_cndmask_b32 v4, v6, v136, s[56:57]
    s_lshl1_add_u32 s58, s50, s52
    s_lshl_b32 s58, s58, 7
    s_add_u32 s58, s58, 8912896
    s_xor_b32 s59, s58, 0x80
    v_mov_b32 v7, 156348
    s_setprio 1
    ds_read_b32 v3, v7
    s_waitcnt lgkmcnt(0)
    v_cmp_gt_u32 vcc, 1, v3
    s_cbranch_vccnz Lst_1115
Lrt_1116:
    s_add_u32 s47, s58, 0
    buffer_load_dword v72, v5, s[20:23], s47 offen sc1
    s_add_u32 s47, s58, 8192
    buffer_load_dword v73, v5, s[20:23], s47 offen sc1
    s_add_u32 s47, s58, 16384
    buffer_load_dword v74, v5, s[20:23], s47 offen sc1
    s_add_u32 s47, s58, 24576
    buffer_load_dword v75, v5, s[20:23], s47 offen sc1
    s_add_u32 s47, s58, 65536
    buffer_load_dword v76, v5, s[20:23], s47 offen sc1
    s_add_u32 s47, s58, 73728
    buffer_load_dword v77, v5, s[20:23], s47 offen sc1
    s_add_u32 s47, s58, 81920
    buffer_load_dword v78, v5, s[20:23], s47 offen sc1
    s_add_u32 s47, s58, 90112
    buffer_load_dword v79, v5, s[20:23], s47 offen sc1
    s_add_u32 s47, s58, 1048576
    buffer_load_dword v80, v5, s[20:23], s47 offen sc1
    s_add_u32 s47, s58, 1056768
    buffer_load_dword v81, v5, s[20:23], s47 offen sc1
    s_add_u32 s47, s58, 1064960
    buffer_load_dword v82, v5, s[20:23], s47 offen sc1
    s_add_u32 s47, s58, 1073152
    buffer_load_dword v83, v5, s[20:23], s47 offen sc1
    s_add_u32 s47, s58, 1114112
    buffer_load_dword v84, v5, s[20:23], s47 offen sc1
    s_add_u32 s47, s58, 1122304
    buffer_load_dword v85, v5, s[20:23], s47 offen sc1
    s_add_u32 s47, s58, 1130496
    buffer_load_dword v86, v5, s[20:23], s47 offen sc1
    s_add_u32 s47, s58, 1138688
    buffer_load_dword v87, v5, s[20:23], s47 offen sc1
    s_add_u32 s47, s58, 1572864
    buffer_load_dword v88, v4, s[20:23], s47 offen sc1
    s_add_u32 s47, s58, 1564672
    buffer_load_dword v89, v6, s[20:23], s47 offen sc1
    s_add_u32 s47, s58, 1556480
    buffer_load_dword v90, v6, s[20:23], s47 offen sc1
    s_add_u32 s47, s58, 1548288
    buffer_load_dword v91, v6, s[20:23], s47 offen sc1
    s_add_u32 s47, s58, 1507328
    buffer_load_dword v92, v6, s[20:23], s47 offen sc1
    s_add_u32 s47, s58, 1499136
    buffer_load_dword v93, v6, s[20:23], s47 offen sc1
    s_add_u32 s47, s58, 1490944
    buffer_load_dword v94, v6, s[20:23], s47 offen sc1
    s_add_u32 s47, s58, 1482752
    buffer_load_dword v95, v6, s[20:23], s47 offen sc1
    s_add_u32 s47, s58, 524288
    buffer_load_dword v96, v4, s[20:23], s47 offen sc1
    s_add_u32 s47, s58, 516096
    buffer_load_dword v97, v6, s[20:23], s47 offen sc1
    s_add_u32 s47, s58, 507904
    buffer_load_dword v98, v6, s[20:23], s47 offen sc1
    s_add_u32 s47, s58, 499712
    buffer_load_dword v99, v6, s[20:23], s47 offen sc1
    s_add_u32 s47, s58, 458752
    buffer_load_dword v100, v6, s[20:23], s47 offen sc1
    s_add_u32 s47, s58, 450560
    buffer_load_dword v101, v6, s[20:23], s47 offen sc1
    s_add_u32 s47, s58, 442368
    buffer_load_dword v102, v6, s[20:23], s47 offen sc1
    s_add_u32 s47, s58, 434176
    buffer_load_dword v103, v6, s[20:23], s47 offen sc1
    s_add_u32 s47, s59, 0
    buffer_load_dword v104, v5, s[20:23], s47 offen sc1
    s_add_u32 s47, s59, 8192
    buffer_load_dword v105, v5, s[20:23], s47 offen sc1
    s_add_u32 s47, s59, 16384
    buffer_load_dword v106, v5, s[20:23], s47 offen sc1
    s_add_u32 s47, s59, 24576
    buffer_load_dword v107, v5, s[20:23], s47 offen sc1
    s_add_u32 s47, s59, 65536
    buffer_load_dword v108, v5, s[20:23], s47 offen sc1
    s_add_u32 s47, s59, 73728
    buffer_load_dword v109, v5, s[20:23], s47 offen sc1
    s_add_u32 s47, s59, 81920
    buffer_load_dword v110, v5, s[20:23], s47 offen sc1
    s_add_u32 s47, s59, 90112
    buffer_load_dword v111, v5, s[20:23], s47 offen sc1
    s_add_u32 s47, s59, 1048576
    buffer_load_dword v112, v5, s[20:23], s47 offen sc1
    s_add_u32 s47, s59, 1056768
    buffer_load_dword v113, v5, s[20:23], s47 offen sc1
    s_add_u32 s47, s59, 1064960
    buffer_load_dword v114, v5, s[20:23], s47 offen sc1
    s_add_u32 s47, s59, 1073152
    buffer_load_dword v115, v5, s[20:23], s47 offen sc1
    s_add_u32 s47, s59, 1114112
    buffer_load_dword v116, v5, s[20:23], s47 offen sc1
    s_add_u32 s47, s59, 1122304
    buffer_load_dword v117, v5, s[20:23], s47 offen sc1
    s_add_u32 s47, s59, 1130496
    buffer_load_dword v118, v5, s[20:23], s47 offen sc1
    s_add_u32 s47, s59, 1138688
    buffer_load_dword v119, v5, s[20:23], s47 offen sc1
    s_add_u32 s47, s59, 1572864
    buffer_load_dword v120, v4, s[20:23], s47 offen sc1
    s_add_u32 s47, s59, 1564672
    buffer_load_dword v121, v6, s[20:23], s47 offen sc1
    s_add_u32 s47, s59, 1556480
    buffer_load_dword v122, v6, s[20:23], s47 offen sc1
    s_add_u32 s47, s59, 1548288
    buffer_load_dword v123, v6, s[20:23], s47 offen sc1
    s_add_u32 s47, s59, 1507328
    buffer_load_dword v124, v6, s[20:23], s47 offen sc1
    s_add_u32 s47, s59, 1499136
    buffer_load_dword v125, v6, s[20:23], s47 offen sc1
    s_add_u32 s47, s59, 1490944
    buffer_load_dword v126, v6, s[20:23], s47 offen sc1
    s_add_u32 s47, s59, 1482752
    buffer_load_dword v127, v6, s[20:23], s47 offen sc1
    s_add_u32 s47, s59, 524288
    buffer_load_dword v128, v4, s[20:23], s47 offen sc1
    s_add_u32 s47, s59, 516096
    buffer_load_dword v129, v6, s[20:23], s47 offen sc1
    s_add_u32 s47, s59, 507904
    buffer_load_dword v130, v6, s[20:23], s47 offen sc1
    s_add_u32 s47, s59, 499712
    buffer_load_dword v131, v6, s[20:23], s47 offen sc1
    s_add_u32 s47, s59, 458752
    buffer_load_dword v132, v6, s[20:23], s47 offen sc1
    s_add_u32 s47, s59, 450560
    buffer_load_dword v133, v6, s[20:23], s47 offen sc1
    s_waitcnt vmcnt(58)
    v_mfma_f32_32x32x16_bf16 v[136:151], v[8:11], v[72:75], 0
    v_mfma_f32_32x32x16_bf16 v[152:167], v[40:43], v[72:75], 0
    s_waitcnt vmcnt(54)
    v_mfma_f32_32x32x16_bf16 v[136:151], v[12:15], v[76:79], v[136:151]
    v_mfma_f32_32x32x16_bf16 v[152:167], v[44:47], v[76:79], v[152:167]
    s_add_u32 s47, s59, 442368
    buffer_load_dword v134, v6, s[20:23], s47 offen sc1
    s_add_u32 s47, s59, 434176
    buffer_load_dword v135, v6, s[20:23], s47 offen sc1
    s_waitcnt vmcnt(52)
    v_mfma_f32_32x32x16_bf16 v[136:151], v[16:19], v[80:83], v[136:151]
    v_mfma_f32_32x32x16_bf16 v[152:167], v[48:51], v[80:83], v[152:167]
    s_waitcnt vmcnt(48)
    v_mfma_f32_32x32x16_bf16 v[136:151], v[20:23], v[84:87], v[136:151]
    v_mfma_f32_32x32x16_bf16 v[152:167], v[52:55], v[84:87], v[152:167]
    s_waitcnt vmcnt(44)
    v_mfma_f32_32x32x16_bf16 v[136:151], v[24:27], v[88:91], v[136:151]
    v_mfma_f32_32x32x16_bf16 v[152:167], v[56:59], v[88:91], v[152:167]
    s_waitcnt vmcnt(40)
    v_mfma_f32_32x32x16_bf16 v[136:151], v[28:31], v[92:95], v[136:151]
    v_mfma_f32_32x32x16_bf16 v[152:167], v[60:63], v[92:95], v[152:167]
    s_waitcnt vmcnt(36)
    v_mfma_f32_32x32x16_bf16 v[136:151], v[32:35], v[96:99], v[136:151]
    v_mfma_f32_32x32x16_bf16 v[152:167], v[64:67], v[96:99], v[152:167]
    s_waitcnt vmcnt(32)
    v_mfma_f32_32x32x16_bf16 v[136:151], v[36:39], v[100:103], v[136:151]
    v_mfma_f32_32x32x16_bf16 v[152:167], v[68:71], v[100:103], v[152:167]
    s_waitcnt vmcnt(28)
    v_mfma_f32_32x32x16_bf16 v[72:87], v[8:11], v[104:107], 0
    v_mfma_f32_32x32x16_bf16 v[88:103], v[40:43], v[104:107], 0
    s_waitcnt vmcnt(24)
    v_mfma_f32_32x32x16_bf16 v[72:87], v[12:15], v[108:111], v[72:87]
    v_mfma_f32_32x32x16_bf16 v[88:103], v[44:47], v[108:111], v[88:103]
    s_waitcnt vmcnt(20)
    v_mfma_f32_32x32x16_bf16 v[72:87], v[16:19], v[112:115], v[72:87]
    v_mfma_f32_32x32x16_bf16 v[88:103], v[48:51], v[112:115], v[88:103]
    s_waitcnt vmcnt(16)
    v_mfma_f32_32x32x16_bf16 v[72:87], v[20:23], v[116:119], v[72:87]
    v_mfma_f32_32x32x16_bf16 v[88:103], v[52:55], v[116:119], v[88:103]
    s_waitcnt vmcnt(12)
    v_mfma_f32_32x32x16_bf16 v[72:87], v[24:27], v[120:123], v[72:87]
    v_mfma_f32_32x32x16_bf16 v[88:103], v[56:59], v[120:123], v[88:103]
    s_waitcnt vmcnt(8)
    v_mfma_f32_32x32x16_bf16 v[72:87], v[28:31], v[124:127], v[72:87]
    v_mfma_f32_32x32x16_bf16 v[88:103], v[60:63], v[124:127], v[88:103]
    s_waitcnt vmcnt(4)
    v_mfma_f32_32x32x16_bf16 v[72:87], v[32:35], v[128:131], v[72:87]
    v_mfma_f32_32x32x16_bf16 v[88:103], v[64:67], v[128:131], v[88:103]
    s_waitcnt vmcnt(0)
    v_mfma_f32_32x32x16_bf16 v[72:87], v[36:39], v[132:135], v[72:87]
    v_mfma_f32_32x32x16_bf16 v[88:103], v[68:71], v[132:135], v[88:103]
    v_lshlrev_b32 v5, 4, v0
    v_cvt_pk_bf16_f32 v8, v136, v137
    v_cvt_pk_bf16_f32 v9, v138, v139
    v_cvt_pk_bf16_f32 v10, v140, v141
    v_cvt_pk_bf16_f32 v11, v142, v143
    v_cvt_pk_bf16_f32 v12, v144, v145
    v_cvt_pk_bf16_f32 v13, v146, v147
    v_cvt_pk_bf16_f32 v14, v148, v149
    v_cvt_pk_bf16_f32 v15, v150, v151
    s_xor_b32 s47, s41, 0
    s_lshl_b32 s47, s47, 13
    s_add_u32 s47, s47, 122976
    v_add_u32 v6, s47, v5
    ds_write_b128 v6, v[8:11]
    ds_write_b128 v6, v[12:15] offset:1024
    v_cvt_pk_bf16_f32 v16, v152, v153
    v_cvt_pk_bf16_f32 v17, v154, v155
    v_cvt_pk_bf16_f32 v18, v156, v157
    v_cvt_pk_bf16_f32 v19, v158, v159
    v_cvt_pk_bf16_f32 v20, v160, v161
    v_cvt_pk_bf16_f32 v21, v162, v163
    v_cvt_pk_bf16_f32 v22, v164, v165
    v_cvt_pk_bf16_f32 v23, v166, v167
    s_xor_b32 s47, s41, 1
    s_lshl_b32 s47, s47, 13
    s_add_u32 s47, s47, 125024
    v_add_u32 v6, s47, v5
    ds_write_b128 v6, v[16:19]
    ds_write_b128 v6, v[20:23] offset:1024
    v_cvt_pk_bf16_f32 v24, v72, v73
    v_cvt_pk_bf16_f32 v25, v74, v75
    v_cvt_pk_bf16_f32 v26, v76, v77
    v_cvt_pk_bf16_f32 v27, v78, v79
    v_cvt_pk_bf16_f32 v28, v80, v81
    v_cvt_pk_bf16_f32 v29, v82, v83
    v_cvt_pk_bf16_f32 v30, v84, v85
    v_cvt_pk_bf16_f32 v31, v86, v87
    s_xor_b32 s47, s41, 2
    s_lshl_b32 s47, s47, 13
    s_add_u32 s47, s47, 127072
    v_add_u32 v6, s47, v5
    ds_write_b128 v6, v[24:27]
    ds_write_b128 v6, v[28:31] offset:1024
    v_cvt_pk_bf16_f32 v32, v88, v89
    v_cvt_pk_bf16_f32 v33, v90, v91
    v_cvt_pk_bf16_f32 v34, v92, v93
    v_cvt_pk_bf16_f32 v35, v94, v95
    v_cvt_pk_bf16_f32 v36, v96, v97
    v_cvt_pk_bf16_f32 v37, v98, v99
    v_cvt_pk_bf16_f32 v38, v100, v101
    v_cvt_pk_bf16_f32 v39, v102, v103
    s_xor_b32 s47, s41, 3
    s_lshl_b32 s47, s47, 13
    s_add_u32 s47, s47, 129120
    v_add_u32 v6, s47, v5
    ds_write_b128 v6, v[32:35]
    ds_write_b128 v6, v[36:39] offset:1024
    v_mov_b32 v3, 1
    ds_write_b32 v1, v3 offset:32
    s_endpgm
Lst_72:
    s_mov_b32 s46, 200000
Llp_74:
    s_sleep 1
    ds_read_b32 v3, v2
    s_waitcnt lgkmcnt(0)
    v_cmp_gt_u32 vcc, 1, v3
    s_cbranch_vccz Lrt_73
    s_sub_u32 s46, s46, 1
    s_cbranch_scc0 Llp_74
    s_branch Lrt_73
Lst_75:
    s_mov_b32 s46, 200000
Llp_77:
    s_sleep 1
    ds_read_b32 v11, v10
    s_waitcnt lgkmcnt(0)
    v_cmp_gt_u32 vcc, 1, v11
    s_cbranch_vccz Lrt_76
    s_sub_u32 s46, s46, 1
    s_cbranch_scc0 Llp_77
    s_branch Lrt_76
Lst_78:
    s_mov_b32 s46, 200000
Llp_80:
    ds_read_b32 v3, v6
    s_waitcnt lgkmcnt(0)
    v_cmp_gt_u32 vcc, 1, v3
    s_cbranch_vccz Lrt_79
    s_sub_u32 s46, s46, 1
    s_cbranch_scc0 Llp_80
    s_branch Lrt_79
Lst_81:
    s_mov_b32 s46, 200000
Llp_83:
    s_sleep 1
    ds_read_b32 v3, v7
    s_waitcnt lgkmcnt(0)
    v_cmp_gt_u32 vcc, 1, v3
    s_cbranch_vccz Lrt_82
    s_sub_u32 s46, s46, 1
    s_cbranch_scc0 Llp_83
    s_branch Lrt_82
Las_85:
    s_mov_b32 s46, 60000
Lap_87:
    s_sleep 4
    s_mov_b32 s55, 1
    s_atomic_add s55, s[60:61], 0 glc
    s_waitcnt lgkmcnt(0)
    s_sub_u32 s55, s55, s44
    s_cmp_lt_u32 s55, 64
    s_cbranch_scc1 Lar_86
    s_sub_u32 s46, s46, 1
    s_cbranch_scc0 Lap_87
    s_branch Lar_86
Las_88:
    s_mov_b32 s46, 60000
Lap_90:
    s_sleep 4
    s_mov_b32 s56, 1
    s_atomic_add s56, s[60:61], 256 glc
    s_waitcnt lgkmcnt(0)
    s_sub_u32 s56, s56, s44
    s_cmp_lt_u32 s56, 64
    s_cbranch_scc1 Lar_89
    s_sub_u32 s46, s46, 1
    s_cbranch_scc0 Lap_90
    s_branch Lar_89
Las_91:
    s_mov_b32 s46, 60000
Lap_93:
    s_sleep 4
    s_mov_b32 s57, 1
    s_atomic_add s57, s[60:61], 512 glc
    s_waitcnt lgkmcnt(0)
    s_sub_u32 s57, s57, s44
    s_cmp_lt_u32 s57, 64
    s_cbranch_scc1 Lar_92
    s_sub_u32 s46, s46, 1
    s_cbranch_scc0 Lap_93
    s_branch Lar_92
Las_94:
    s_mov_b32 s46, 60000
Lap_96:
    s_sleep 4
    s_mov_b32 s58, 1
    s_atomic_add s58, s[60:61], 768 glc
    s_waitcnt lgkmcnt(0)
    s_sub_u32 s58, s58, s44
    s_cmp_lt_u32 s58, 64
    s_cbranch_scc1 Lar_95
    s_sub_u32 s46, s46, 1
    s_cbranch_scc0 Lap_96
    s_branch Lar_95
Las_97:
    s_mov_b32 s46, 60000
Lap_99:
    s_sleep 4
    s_mov_b32 s59, 1
    s_atomic_add s59, s[62:63], 0 glc
    s_waitcnt lgkmcnt(0)
    s_sub_u32 s59, s59, s44
    s_cmp_lt_u32 s59, 64
    s_cbranch_scc1 Lar_98
    s_sub_u32 s46, s46, 1
    s_cbranch_scc0 Lap_99
    s_branch Lar_98
Lst_100:
    s_mov_b32 s46, 200000
Llp_102:
    s_sleep 1
    ds_read_b32 v3, v9
    s_waitcnt lgkmcnt(0)
    v_cmp_gt_u32 vcc, 1, v3
    s_cbranch_vccz Lrt_101
    s_sub_u32 s46, s46, 1
    s_cbranch_scc0 Llp_102
    s_branch Lrt_101
Lst_104:
    s_mov_b32 s46, 200000
Llp_106:
    ds_read_b32 v3, v2
    s_waitcnt lgkmcnt(0)
    v_cmp_gt_u32 vcc, 2, v3
    s_cbranch_vccz Lrt_105
    s_sub_u32 s46, s46, 1
    s_cbranch_scc0 Llp_106
    s_branch Lrt_105
Lst_109:
    s_mov_b32 s46, 200000
Llp_111:
    ds_read_b32 v3, v2
    s_waitcnt lgkmcnt(0)
    v_cmp_gt_u32 vcc, 4, v3
    s_cbranch_vccz Lrt_110
    s_sub_u32 s46, s46, 1
    s_cbranch_scc0 Llp_111
    s_branch Lrt_110
Lp2s_107:
    v_and_b32 v10, 31, v0
    v_lshrrev_b32 v11, 5, v0
    v_lshl_add_u32 v10, v11, 6, v10
    s_and_b32 s47, s41, 1
    s_lshl_b32 s47, s47, 13
    s_lshr_b32 s48, s41, 1
    s_mul_i32 s48, s48, 40992
    s_add_u32 s47, s47, s48
    s_add_u32 s47, s47, 12288
    v_lshlrev_b32 v11, 4, v10
    v_add_u32 v11, s47, v11
    s_lshl_b32 s47, s41, 9
    v_add_u32 v10, s47, v10
    s_mov_b32 s47, 0x05040100
    s_mov_b32 s48, 0x07060302
    v_perm_b32 v96, v148, v144, s47
    v_perm_b32 v97, v156, v152, s47
    v_perm_b32 v98, v148, v144, s48
    v_perm_b32 v99, v156, v152, s48
    v_perm_b32 v100, v149, v145, s47
    v_perm_b32 v101, v157, v153, s47
    v_perm_b32 v102, v149, v145, s48
    v_perm_b32 v103, v157, v153, s48
    v_perm_b32 v104, v150, v146, s47
    v_perm_b32 v105, v158, v154, s47
    v_perm_b32 v106, v150, v146, s48
    v_perm_b32 v107, v158, v154, s48
    v_perm_b32 v108, v151, v147, s47
    v_perm_b32 v109, v159, v155, s47
    v_perm_b32 v110, v151, v147, s48
    v_perm_b32 v111, v159, v155, s48
    ds_write_b64 v11, v[128:129] offset:0
    ds_write_b64 v11, v[96:97] offset:8
    ds_write_b64 v11, v[130:131] offset:512
    ds_write_b64 v11, v[98:99] offset:520
    ds_write_b64 v11, v[132:133] offset:2048
    ds_write_b64 v11, v[100:101] offset:2056
    ds_write_b64 v11, v[134:135] offset:2560
    ds_write_b64 v11, v[102:103] offset:2568
    ds_write_b64 v11, v[136:137] offset:4096
    ds_write_b64 v11, v[104:105] offset:4104
    ds_write_b64 v11, v[138:139] offset:4608
    ds_write_b64 v11, v[106:107] offset:4616
    ds_write_b64 v11, v[140:141] offset:6144
    ds_write_b64 v11, v[108:109] offset:6152
    ds_write_b64 v11, v[142:143] offset:6656
    ds_write_b64 v11, v[110:111] offset:6664
    v_mov_b32 v3, 3
    ds_write_b32 v1, v3
    s_mov_b32 s47, 24608
    v_sub_u32 v160, 2048, v10
    v_and_b32 v160, 0x7ff, v160
    v_lshrrev_b32 v12, 10, v160
    v_lshlrev_b32 v160, 4, v160
    v_mad_u32_u24 v160, v12, s47, v160
    v_sub_u32 v161, 2016, v10
    v_and_b32 v161, 0x7ff, v161
    v_lshrrev_b32 v12, 10, v161
    v_lshlrev_b32 v161, 4, v161
    v_mad_u32_u24 v161, v12, s47, v161
    v_sub_u32 v162, 1920, v10
    v_and_b32 v162, 0x7ff, v162
    v_lshrrev_b32 v12, 10, v162
    v_lshlrev_b32 v162, 4, v162
    v_mad_u32_u24 v162, v12, s47, v162
    v_sub_u32 v163, 1888, v10
    v_and_b32 v163, 0x7ff, v163
    v_lshrrev_b32 v12, 10, v163
    v_lshlrev_b32 v163, 4, v163
    v_mad_u32_u24 v163, v12, s47, v163
    v_sub_u32 v164, 1792, v10
    v_and_b32 v164, 0x7ff, v164
    v_lshrrev_b32 v12, 10, v164
    v_lshlrev_b32 v164, 4, v164
    v_mad_u32_u24 v164, v12, s47, v164
    v_sub_u32 v165, 1760, v10
    v_and_b32 v165, 0x7ff, v165
    v_lshrrev_b32 v12, 10, v165
    v_lshlrev_b32 v165, 4, v165
    v_mad_u32_u24 v165, v12, s47, v165
    v_sub_u32 v166, 1664, v10
    v_and_b32 v166, 0x7ff, v166
    v_lshrrev_b32 v12, 10, v166
    v_lshlrev_b32 v166, 4, v166
    v_mad_u32_u24 v166, v12, s47, v166
    v_sub_u32 v167, 1632, v10
    v_and_b32 v167, 0x7ff, v167
    v_lshrrev_b32 v12, 10, v167
    v_lshlrev_b32 v167, 4, v167
    v_mad_u32_u24 v167, v12, s47, v167
    ds_read_b32 v3, v2
    s_waitcnt lgkmcnt(0)
    v_cmp_gt_u32 vcc, 3, v3
    s_cbranch_vccnz Lst_1112
Lrt_1113:
    ds_read_b128 v[112:115], v160 offset:12288
    ds_read_b128 v[116:119], v161 offset:12288
    ds_read_b128 v[120:123], v162 offset:12288
    ds_read_b128 v[124:127], v163 offset:12288
    ds_read_b128 v[144:147], v164 offset:12288
    ds_read_b128 v[148:151], v165 offset:12288
    ds_read_b128 v[152:155], v166 offset:12288
    ds_read_b128 v[156:159], v167 offset:12288
    v_lshlrev_b32 v160, 16, v96
    v_and_b32 v161, 0xffff0000, v96
    v_lshlrev_b32 v162, 16, v97
    v_and_b32 v163, 0xffff0000, v97
    s_waitcnt lgkmcnt(7)
    v_lshlrev_b32 v164, 16, v114
    v_and_b32 v165, 0xffff0000, v114
    v_lshlrev_b32 v166, 16, v115
    v_and_b32 v167, 0xffff0000, v115
    v_pk_add_f32 v[160:161], v[160:161], v[164:165] neg_hi:[0,1]
    v_pk_add_f32 v[162:163], v[162:163], v[166:167] neg_hi:[0,1]
    v_pk_add_f32 v[164:165], v[160:161], v[162:163]
    v_pk_add_f32 v[166:167], v[160:161], v[162:163] neg_lo:[0,1] neg_hi:[0,1]
    v_pk_mul_f32 v[160:161], v[164:165], v[128:129] op_sel_hi:[1,0]
    v_pk_fma_f32 v[160:161], v[164:165], v[128:129], v[160:161] op_sel:[1,1,0] op_sel_hi:[0,1,1] neg_lo:[1,0,0]
    v_pk_fma_f32 v[160:161], v[166:167], v[112:113], v[160:161] op_sel_hi:[1,0,1]
    v_pk_fma_f32 v[128:129], v[166:167], v[112:113], v[160:161] op_sel:[1,1,0] op_sel_hi:[0,1,1] neg_hi:[1,0,0]
    v_lshlrev_b32 v160, 16, v98
    v_and_b32 v161, 0xffff0000, v98
    v_lshlrev_b32 v162, 16, v99
    v_and_b32 v163, 0xffff0000, v99
    s_waitcnt lgkmcnt(6)
    v_lshlrev_b32 v164, 16, v118
    v_and_b32 v165, 0xffff0000, v118
    v_lshlrev_b32 v166, 16, v119
    v_and_b32 v167, 0xffff0000, v119
    v_pk_add_f32 v[160:161], v[160:161], v[164:165] neg_hi:[0,1]
    v_pk_add_f32 v[162:163], v[162:163], v[166:167] neg_hi:[0,1]
    v_pk_add_f32 v[164:165], v[160:161], v[162:163]
    v_pk_add_f32 v[166:167], v[160:161], v[162:163] neg_lo:[0,1] neg_hi:[0,1]
    v_pk_mul_f32 v[160:161], v[164:165], v[130:131] op_sel_hi:[1,0]
    v_pk_fma_f32 v[160:161], v[164:165], v[130:131], v[160:161] op_sel:[1,1,0] op_sel_hi:[0,1,1] neg_lo:[1,0,0]
    v_pk_fma_f32 v[160:161], v[166:167], v[116:117], v[160:161] op_sel_hi:[1,0,1]
    v_pk_fma_f32 v[130:131], v[166:167], v[116:117], v[160:161] op_sel:[1,1,0] op_sel_hi:[0,1,1] neg_hi:[1,0,0]
    v_lshlrev_b32 v160, 16, v100
    v_and_b32 v161, 0xffff0000, v100
    v_lshlrev_b32 v162, 16, v101
    v_and_b32 v163, 0xffff0000, v101
    s_waitcnt lgkmcnt(5)
    v_lshlrev_b32 v164, 16, v122
    v_and_b32 v165, 0xffff0000, v122
    v_lshlrev_b32 v166, 16, v123
    v_and_b32 v167, 0xffff0000, v123
    v_pk_add_f32 v[160:161], v[160:161], v[164:165] neg_hi:[0,1]
    v_pk_add_f32 v[162:163], v[162:163], v[166:167] neg_hi:[0,1]
    v_pk_add_f32 v[164:165], v[160:161], v[162:163]
    v_pk_add_f32 v[166:167], v[160:161], v[162:163] neg_lo:[0,1] neg_hi:[0,1]
    v_pk_mul_f32 v[160:161], v[164:165], v[132:133] op_sel_hi:[1,0]
    v_pk_fma_f32 v[160:161], v[164:165], v[132:133], v[160:161] op_sel:[1,1,0] op_sel_hi:[0,1,1] neg_lo:[1,0,0]
    v_pk_fma_f32 v[160:161], v[166:167], v[120:121], v[160:161] op_sel_hi:[1,0,1]
    v_pk_fma_f32 v[132:133], v[166:167], v[120:121], v[160:161] op_sel:[1,1,0] op_sel_hi:[0,1,1] neg_hi:[1,0,0]
    v_lshlrev_b32 v160, 16, v102
    v_and_b32 v161, 0xffff0000, v102
    v_lshlrev_b32 v162, 16, v103
    v_and_b32 v163, 0xffff0000, v103
    s_waitcnt lgkmcnt(4)
    v_lshlrev_b32 v164, 16, v126
    v_and_b32 v165, 0xffff0000, v126
    v_lshlrev_b32 v166, 16, v127
    v_and_b32 v167, 0xffff0000, v127
    v_pk_add_f32 v[160:161], v[160:161], v[164:165] neg_hi:[0,1]
    v_pk_add_f32 v[162:163], v[162:163], v[166:167] neg_hi:[0,1]
    v_pk_add_f32 v[164:165], v[160:161], v[162:163]
    v_pk_add_f32 v[166:167], v[160:161], v[162:163] neg_lo:[0,1] neg_hi:[0,1]
    v_pk_mul_f32 v[160:161], v[164:165], v[134:135] op_sel_hi:[1,0]
    v_pk_fma_f32 v[160:161], v[164:165], v[134:135], v[160:161] op_sel:[1,1,0] op_sel_hi:[0,1,1] neg_lo:[1,0,0]
    v_pk_fma_f32 v[160:161], v[166:167], v[124:125], v[160:161] op_sel_hi:[1,0,1]
    v_pk_fma_f32 v[134:135], v[166:167], v[124:125], v[160:161] op_sel:[1,1,0] op_sel_hi:[0,1,1] neg_hi:[1,0,0]
    v_lshlrev_b32 v160, 16, v104
    v_and_b32 v161, 0xffff0000, v104
    v_lshlrev_b32 v162, 16, v105
    v_and_b32 v163, 0xffff0000, v105
    s_waitcnt lgkmcnt(3)
    v_lshlrev_b32 v164, 16, v146
    v_and_b32 v165, 0xffff0000, v146
    v_lshlrev_b32 v166, 16, v147
    v_and_b32 v167, 0xffff0000, v147
    v_pk_add_f32 v[160:161], v[160:161], v[164:165] neg_hi:[0,1]
    v_pk_add_f32 v[162:163], v[162:163], v[166:167] neg_hi:[0,1]
    v_pk_add_f32 v[164:165], v[160:161], v[162:163]
    v_pk_add_f32 v[166:167], v[160:161], v[162:163] neg_lo:[0,1] neg_hi:[0,1]
    v_pk_mul_f32 v[160:161], v[164:165], v[136:137] op_sel_hi:[1,0]
    v_pk_fma_f32 v[160:161], v[164:165], v[136:137], v[160:161] op_sel:[1,1,0] op_sel_hi:[0,1,1] neg_lo:[1,0,0]
    v_pk_fma_f32 v[160:161], v[166:167], v[144:145], v[160:161] op_sel_hi:[1,0,1]
    v_pk_fma_f32 v[136:137], v[166:167], v[144:145], v[160:161] op_sel:[1,1,0] op_sel_hi:[0,1,1] neg_hi:[1,0,0]
    v_lshlrev_b32 v160, 16, v106
    v_and_b32 v161, 0xffff0000, v106
    v_lshlrev_b32 v162, 16, v107
    v_and_b32 v163, 0xffff0000, v107
    s_waitcnt lgkmcnt(2)
    v_lshlrev_b32 v164, 16, v150
    v_and_b32 v165, 0xffff0000, v150
    v_lshlrev_b32 v166, 16, v151
    v_and_b32 v167, 0xffff0000, v151
    v_pk_add_f32 v[160:161], v[160:161], v[164:165] neg_hi:[0,1]
    v_pk_add_f32 v[162:163], v[162:163], v[166:167] neg_hi:[0,1]
    v_pk_add_f32 v[164:165], v[160:161], v[162:163]
    v_pk_add_f32 v[166:167], v[160:161], v[162:163] neg_lo:[0,1] neg_hi:[0,1]
    v_pk_mul_f32 v[160:161], v[164:165], v[138:139] op_sel_hi:[1,0]
    v_pk_fma_f32 v[160:161], v[164:165], v[138:139], v[160:161] op_sel:[1,1,0] op_sel_hi:[0,1,1] neg_lo:[1,0,0]
    v_pk_fma_f32 v[160:161], v[166:167], v[148:149], v[160:161] op_sel_hi:[1,0,1]
    v_pk_fma_f32 v[138:139], v[166:167], v[148:149], v[160:161] op_sel:[1,1,0] op_sel_hi:[0,1,1] neg_hi:[1,0,0]
    v_lshlrev_b32 v160, 16, v108
    v_and_b32 v161, 0xffff0000, v108
    v_lshlrev_b32 v162, 16, v109
    v_and_b32 v163, 0xffff0000, v109
    s_waitcnt lgkmcnt(1)
    v_lshlrev_b32 v164, 16, v154
    v_and_b32 v165, 0xffff0000, v154
    v_lshlrev_b32 v166, 16, v155
    v_and_b32 v167, 0xffff0000, v155
    v_pk_add_f32 v[160:161], v[160:161], v[164:165] neg_hi:[0,1]
    v_pk_add_f32 v[162:163], v[162:163], v[166:167] neg_hi:[0,1]
    v_pk_add_f32 v[164:165], v[160:161], v[162:163]
    v_pk_add_f32 v[166:167], v[160:161], v[162:163] neg_lo:[0,1] neg_hi:[0,1]
    v_pk_mul_f32 v[160:161], v[164:165], v[140:141] op_sel_hi:[1,0]
    v_pk_fma_f32 v[160:161], v[164:165], v[140:141], v[160:161] op_sel:[1,1,0] op_sel_hi:[0,1,1] neg_lo:[1,0,0]
    v_pk_fma_f32 v[160:161], v[166:167], v[152:153], v[160:161] op_sel_hi:[1,0,1]
    v_pk_fma_f32 v[140:141], v[166:167], v[152:153], v[160:161] op_sel:[1,1,0] op_sel_hi:[0,1,1] neg_hi:[1,0,0]
    v_lshlrev_b32 v160, 16, v110
    v_and_b32 v161, 0xffff0000, v110
    v_lshlrev_b32 v162, 16, v111
    v_and_b32 v163, 0xffff0000, v111
    s_waitcnt lgkmcnt(0)
    v_lshlrev_b32 v164, 16, v158
    v_and_b32 v165, 0xffff0000, v158
    v_lshlrev_b32 v166, 16, v159
    v_and_b32 v167, 0xffff0000, v159
    v_pk_add_f32 v[160:161], v[160:161], v[164:165] neg_hi:[0,1]
    v_pk_add_f32 v[162:163], v[162:163], v[166:167] neg_hi:[0,1]
    v_pk_add_f32 v[164:165], v[160:161], v[162:163]
    v_pk_add_f32 v[166:167], v[160:161], v[162:163] neg_lo:[0,1] neg_hi:[0,1]
    v_pk_mul_f32 v[160:161], v[164:165], v[142:143] op_sel_hi:[1,0]
    v_pk_fma_f32 v[160:161], v[164:165], v[142:143], v[160:161] op_sel:[1,1,0] op_sel_hi:[0,1,1] neg_lo:[1,0,0]
    v_pk_fma_f32 v[160:161], v[166:167], v[156:157], v[160:161] op_sel_hi:[1,0,1]
    v_pk_fma_f32 v[142:143], v[166:167], v[156:157], v[160:161] op_sel:[1,1,0] op_sel_hi:[0,1,1] neg_hi:[1,0,0]
    v_mul_f32 v112, 0x3e800000, v128
    v_mul_f32 v113, 0x3e800000, v129
    v_mul_f32 v114, 0x3e800000, v130
    v_mul_f32 v115, 0x3e800000, v131
    v_mul_f32 v116, 0x3e800000, v132
    v_mul_f32 v117, 0x3e800000, v133
    v_mul_f32 v118, 0x3e800000, v134
    v_mul_f32 v119, 0x3e800000, v135
    v_mul_f32 v120, 0x3e800000, v136
    v_mul_f32 v121, 0x3e800000, v137
    v_mul_f32 v122, 0x3e800000, v138
    v_mul_f32 v123, 0x3e800000, v139
    v_mul_f32 v124, 0x3e800000, v140
    v_mul_f32 v125, 0x3e800000, v141
    v_mul_f32 v126, 0x3e800000, v142
    v_mul_f32 v127, 0x3e800000, v143
    s_waitcnt vmcnt(0) lgkmcnt(0)
    s_branch Lp2b_108
Lst_1112:
    s_mov_b32 s46, 200000
Llp_1114:
    ds_read_b32 v3, v2
    s_waitcnt lgkmcnt(0)
    v_cmp_gt_u32 vcc, 3, v3
    s_cbranch_vccz Lrt_1113
    s_sub_u32 s46, s46, 1
    s_cbranch_scc0 Llp_1114
    s_branch Lrt_1113
Lst_1115:
    s_mov_b32 s46, 200000
Llp_1117:
    s_sleep 1
    ds_read_b32 v3, v7
    s_waitcnt lgkmcnt(0)
    v_cmp_gt_u32 vcc, 1, v3
    s_cbranch_vccz Lrt_1116
    s_sub_u32 s46, s46, 1
    s_cbranch_scc0 Llp_1117
    s_branch Lrt_1116
Lcomp_4:
    s_setprio 2
    s_lshl_b32 s47, s41, 2
    s_add_u32 s47, s47, 156288
    v_and_b32 v10, 1, v0
    v_lshlrev_b32 v7, 2, v10
    v_add_u32 v7, 156256, v7
    v_mov_b32 v8, s47
    s_waitcnt lgkmcnt(0)
    s_or_b32 s47, s2, 60
    s_cmp_eq_u32 s47, 0xff
    s_cbranch_scc1 Lcskip_1118
    s_lshr_b32 s52, s41, 1
    s_and_b32 s53, s41, 1
    s_lshl_b32 s47, s52, 13
    s_add_u32 s47, s47, 12288
    s_lshl_b32 s48, s52, 5
    v_and_b32 v10, 31, v0
    v_lshrrev_b32 v11, 5, v0
    v_bfe_u32 v12, v0, 1, 3
    v_xor_b32 v11, v11, v12
    v_lshlrev_b32 v10, 7, v10
    v_lshl_add_u32 v10, v11, 4, v10
    v_xor_b32 v10, s48, v10
    v_xor_b32 v2, 0, v10
    v_add_u32 v2, s47, v2
    v_xor_b32 v3, 32, v10
    v_add_u32 v3, s47, v3
    v_xor_b32 v4, 64, v10
    v_add_u32 v4, s47, v4
    v_xor_b32 v5, 96, v10
    v_add_u32 v5, s47, v5
    s_mul_i32 s47, s53, 96
    s_mul_i32 s48, s52, 3072
    s_add_u32 s49, s47, s48
    v_bfe_u32 v10, v0, 4, 1
    v_mul_u32_u24 v10, 28704, v10
    v_lshrrev_b32 v11, 5, v0
    v_bfe_u32 v12, v0, 2, 2
    v_lshl_add_u32 v11, v11, 3, v12
    v_mul_u32_u24 v11, 192, v11
    v_add_u32 v10, v10, v11
    v_and_b32 v11, 1, v0
    v_bfe_u32 v12, v0, 1, 1
    v_lshl_add_u32 v11, v11, 1, v12
    v_lshl_add_u32 v6, v11, 3, v10
    s_sub_u32 s47, s47, s48
    s_add_u32 s47, s47, 3072
    v_add_u32 v1, s47, v6
    v_add_u32 v6, s49, v6
    v_bfe_u32 v10, v0, 2, 2
    v_lshrrev_b32 v11, 4, v0
    v_cmp_eq_u32 vcc, v10, v11
    v_mov_b32 v11, 0x3f803f80
    s_nop 0
    v_cndmask_b32 v164, 0, v11, vcc
    v_cndmask_b32 v165, 0, v11, vcc
    v_cndmask_b32 v166, 0, v11, vcc
    v_cndmask_b32 v167, 0, v11, vcc
    s_lshr_b32 s50, s42, 2
    s_lshl_b32 s50, s50, 3
    s_and_b32 s47, s43, 7
    s_add_u32 s50, s50, s47
    s_and_b32 s51, s42, 3
    s_lshl_b32 s51, s51, 2
    s_lshr_b32 s47, s43, 3
    s_add_u32 s51, s51, s47
    s_mov_b32 s20, s82
    s_mov_b32 s21, s83
    s_mov_b32 s22, 16777216
    s_mov_b32 s23, 0x00020000
    s_lshl1_add_u32 s60, s50, s52
    v_lshlrev_b32 v12, 2, v0
    s_mul_i32 s47, s41, 768
    s_add_u32 s47, s47, 158560
    v_add_u32 v13, s47, v12
    s_xor_b32 s48, s41, 2
    s_mul_i32 s47, s48, 768
    s_add_u32 s47, s47, 158560
    v_add_u32 v12, s47, v12
    s_lshl_b32 s47, s41, 2
    s_add_u32 s47, s47, 156400
    v_mov_b32 v14, s47
    s_lshl_b32 s47, s48, 2
    s_add_u32 s47, s47, 156400
    v_and_b32 v10, 1, v0
    v_cmp_eq_u32 vcc, 0, v10
    v_mov_b32 v10, s47
    v_mov_b32 v11, 156336
    v_cndmask_b32 v15, v10, v11, vcc
    v_mov_b32 v15, 156336
    v_mov_b32 v154, 0
    v_mov_b32 v155, 0
    v_mov_b32 v158, 0
    v_mov_b32 v159, 0
    v_mov_b32 v162, 0
    v_mov_b32 v163, 0
    v_bfe_u32 v104, v0, 1, 3
    s_lshl_b32 s47, s41, 3
    v_add_u32 v104, s47, v104
    v_mul_u32_u24 v105, 1040, v104
    v_and_b32 v101, 1, v0
    v_lshl_add_u32 v105, v101, 6, v105
    v_lshrrev_b32 v101, 4, v0
    v_lshl_add_u32 v105, v101, 4, v105
    v_add_u32 v105, 122976, v105
    s_lshl_b32 s47, s41, 2
    s_add_u32 s47, s47, 156320
    v_mov_b32 v103, s47
    v_mov_b32 v108, 0x3f803f80
    v_mov_b32 v109, 0x3f803f80
    v_mov_b32 v110, 0x3f803f80
    v_mov_b32 v111, 0x3f803f80
    v_lshlrev_b32 v106, 2, v104
    v_add_u32 v106, 161632, v106
    v_lshlrev_b32 v107, 4, v104
    v_add_u32 v107, 161888, v107
    s_mov_b32 s56, 0xaaaaaaaa
    s_mov_b32 s57, 0xaaaaaaaa
    s_mov_b32 s58, 0xcccccccc
    s_mov_b32 s59, 0xcccccccc
    ds_read_b32 v100, v103
    s_waitcnt lgkmcnt(0)
    v_cmp_gt_u32 vcc, 1, v100
    s_cbranch_vccnz Lst_1120
Lrt_1121:
    s_setprio 3
    ds_read_b128 v[60:63], v105 offset:0
    ds_read_b128 v[64:67], v105 offset:128
    ds_read_b128 v[68:71], v105 offset:256
    ds_read_b128 v[72:75], v105 offset:384
    ds_read_b128 v[76:79], v105 offset:512
    ds_read_b128 v[80:83], v105 offset:640
    ds_read_b128 v[84:87], v105 offset:768
    ds_read_b128 v[88:91], v105 offset:896
    s_waitcnt lgkmcnt(7)
    v_mfma_f32_16x16x32_bf16 v[92:95], v[60:63], v[60:63], 0
    v_mfma_f32_16x16x32_bf16 v[96:99], v[60:63], v[108:111], 0
    s_waitcnt lgkmcnt(6)
    v_mfma_f32_16x16x32_bf16 v[92:95], v[64:67], v[64:67], v[92:95]
    v_mfma_f32_16x16x32_bf16 v[96:99], v[64:67], v[108:111], v[96:99]
    s_waitcnt lgkmcnt(5)
    v_mfma_f32_16x16x32_bf16 v[92:95], v[68:71], v[68:71], v[92:95]
    v_mfma_f32_16x16x32_bf16 v[96:99], v[68:71], v[108:111], v[96:99]
    s_waitcnt lgkmcnt(4)
    v_mfma_f32_16x16x32_bf16 v[92:95], v[72:75], v[72:75], v[92:95]
    v_mfma_f32_16x16x32_bf16 v[96:99], v[72:75], v[108:111], v[96:99]
    s_waitcnt lgkmcnt(3)
    v_mfma_f32_16x16x32_bf16 v[92:95], v[76:79], v[76:79], v[92:95]
    v_mfma_f32_16x16x32_bf16 v[96:99], v[76:79], v[108:111], v[96:99]
    s_waitcnt lgkmcnt(2)
    v_mfma_f32_16x16x32_bf16 v[92:95], v[80:83], v[80:83], v[92:95]
    v_mfma_f32_16x16x32_bf16 v[96:99], v[80:83], v[108:111], v[96:99]
    s_waitcnt lgkmcnt(1)
    v_mfma_f32_16x16x32_bf16 v[92:95], v[84:87], v[84:87], v[92:95]
    v_mfma_f32_16x16x32_bf16 v[96:99], v[84:87], v[108:111], v[96:99]
    s_waitcnt lgkmcnt(0)
    v_mfma_f32_16x16x32_bf16 v[92:95], v[88:91], v[88:91], v[92:95]
    v_mfma_f32_16x16x32_bf16 v[96:99], v[88:91], v[108:111], v[96:99]
    s_nop 10
    v_cndmask_b32 v92, v92, v93, s[56:57]
    v_cndmask_b32 v94, v94, v95, s[56:57]
    v_cndmask_b32 v92, v92, v94, s[58:59]
    v_cndmask_b32 v96, v96, v97, s[56:57]
    v_cndmask_b32 v98, v98, v99, s[56:57]
    v_cndmask_b32 v96, v96, v98, s[58:59]
    v_add_f32_dpp v92, v92, v92 quad_perm:[1,0,3,2] row_mask:0xf bank_mask:0xf
    s_nop 0
    v_add_f32_dpp v96, v96, v96 quad_perm:[1,0,3,2] row_mask:0xf bank_mask:0xf
    v_mul_f32 v96, 0x3b000000, v96
    v_mul_f32 v100, v96, v96
    v_mul_f32 v92, 0x3b000000, v92
    v_sub_f32 v92, v92, v100
    v_max_f32 v92, 0, v92
    v_cvt_pk_bf16_f32 v92, v92, v92
    v_and_b32 v92, 0xffff0000, v92
    v_add_f32 v92, 0x3727c5ac, v92
    v_cvt_pk_bf16_f32 v92, v92, v92
    v_and_b32 v92, 0xffff0000, v92
    v_sqrt_f32 v92, v92
    s_nop 0
    v_cvt_pk_bf16_f32 v92, v92, v92
    v_and_b32 v92, 0xffff0000, v92
    v_cvt_pk_bf16_f32 v96, v96, v96
    v_and_b32 v96, 0xffff0000, v96
    v_rcp_f32 v100, v92
    v_cvt_pk_bf16_f32 v60, -v96, -v96
    v_mul_f32 v63, v92, v92
    v_mul_f32 v62, 0xbfb8aa3b, v100
    v_mul_f32 v100, 0x36000000, v100
    v_mov_b32 v61, v60
    v_and_b32 v62, 0xffffff00, v62
    v_mul_f32 v102, -v96, v100
    s_mov_b32 exec_lo, 0x00f0000f
    s_mov_b32 exec_hi, 0xf0000f00
    ds_write2_b32 v106, v100, v102 offset0:0 offset1:32
    ds_write_b128 v107, v[60:63]
    s_mov_b64 exec, -1
    v_mov_b32 v101, 1
    ds_write_b32 v103, v101 offset:160
    s_setprio 2
    v_add_u32 v103, 144, v103
    ds_read_b32 v9, v103
    s_waitcnt lgkmcnt(0)
    v_cmp_gt_u32 vcc, 1, v9
    s_cbranch_vccnz Lst_1123
Lrt_1124:
    ds_read_b32 v9, v7
    s_waitcnt lgkmcnt(0)
    v_cmp_gt_u32 vcc, 1, v9
    s_cbranch_vccnz Lst_1126
Lrt_1127:
    ds_read_b64_tr_b16 v[24:25], v6 offset:0
    ds_read_b64_tr_b16 v[26:27], v6 offset:768
    ds_read_b128 v[16:19], v2 offset:0
    ds_read_b128 v[20:23], v2 offset:4096
    ds_read_b64_tr_b16 v[28:29], v6 offset:32
    ds_read_b64_tr_b16 v[30:31], v6 offset:800
    ds_read_b64_tr_b16 v[32:33], v6 offset:64
    ds_read_b64_tr_b16 v[34:35], v6 offset:832
    ds_read_b64_tr_b16 v[44:45], v1 offset:0
    ds_read_b64_tr_b16 v[46:47], v1 offset:768
    ds_read_b128 v[36:39], v3 offset:0
    ds_read_b128 v[40:43], v3 offset:4096
    ds_read_b64_tr_b16 v[48:49], v1 offset:32
    ds_read_b64_tr_b16 v[50:51], v1 offset:800
    ds_read_b64_tr_b16 v[52:53], v1 offset:64
    ds_read_b64_tr_b16 v[54:55], v1 offset:832
    s_mul_i32 s54, s60, 176128
    s_lshl1_add_u32 s55, s51, s53
    s_mul_i32 s56, s55, 3072
    s_add_u32 s54, s54, s56
    s_lshl1_add_u32 s57, s60, s53
    s_mul_i32 s62, s57, 1536
    s_add_u32 s62, s62, 15073280
    s_mul_i32 s56, s55, 3
    s_waitcnt lgkmcnt(13)
    v_mfma_f32_32x32x16_bf16 v[56:71], v[24:27], v[16:19], 0
    s_waitcnt lgkmcnt(12)
    v_mfma_f32_32x32x16_bf16 v[72:87], v[24:27], v[20:23], 0
    ds_read_b64_tr_b16 v[24:25], v6 offset:6144
    ds_read_b64_tr_b16 v[26:27], v6 offset:6912
    s_waitcnt lgkmcnt(12)
    v_mfma_f32_32x32x16_bf16 v[88:103], v[28:31], v[16:19], 0
    v_mfma_f32_32x32x16_bf16 v[104:119], v[28:31], v[20:23], 0
    ds_read_b64_tr_b16 v[28:29], v6 offset:6176
    ds_read_b64_tr_b16 v[30:31], v6 offset:6944
    s_waitcnt lgkmcnt(12)
    v_mfma_f32_32x32x16_bf16 v[120:135], v[32:35], v[16:19], 0
    ds_read_b128 v[16:19], v4 offset:0
    v_mfma_f32_32x32x16_bf16 v[136:151], v[32:35], v[20:23], 0
    ds_read_b128 v[20:23], v4 offset:4096
    ds_read_b64_tr_b16 v[32:33], v6 offset:6208
    ds_read_b64_tr_b16 v[34:35], v6 offset:6976
    ds_read_b32 v9, v7
    s_waitcnt lgkmcnt(14)
    v_mfma_f32_32x32x16_bf16 v[56:71], v[44:47], v[36:39], v[56:71]
    s_waitcnt lgkmcnt(13)
    v_mfma_f32_32x32x16_bf16 v[72:87], v[44:47], v[40:43], v[72:87]
    ds_read_b64_tr_b16 v[44:45], v1 offset:6144
    ds_read_b64_tr_b16 v[46:47], v1 offset:6912
    s_waitcnt lgkmcnt(13)
    v_mfma_f32_32x32x16_bf16 v[88:103], v[48:51], v[36:39], v[88:103]
    v_mfma_f32_32x32x16_bf16 v[104:119], v[48:51], v[40:43], v[104:119]
    ds_read_b64_tr_b16 v[48:49], v1 offset:6176
    ds_read_b64_tr_b16 v[50:51], v1 offset:6944
    s_waitcnt lgkmcnt(13)
    v_mfma_f32_32x32x16_bf16 v[120:135], v[52:55], v[36:39], v[120:135]
    ds_read_b128 v[36:39], v5 offset:0
    v_mfma_f32_32x32x16_bf16 v[136:151], v[52:55], v[40:43], v[136:151]
    ds_read_b128 v[40:43], v5 offset:4096
    ds_read_b64_tr_b16 v[52:53], v1 offset:6208
    ds_read_b64_tr_b16 v[54:55], v1 offset:6976
    v_mov_b32 v10, 1
    ds_write_b32 v8, v10
    s_waitcnt lgkmcnt(9)
    v_cmp_gt_u32 vcc, 2, v9
    s_cbranch_vccnz Lst_1129
Lrt_1130:
    v_add_u32 v2, 40992, v2
    v_add_u32 v3, 40992, v3
    v_add_u32 v4, 40992, v4
    v_add_u32 v5, 40992, v5
    v_add_u32 v6, 40992, v6
    v_add_u32 v1, 40992, v1
    v_mfma_f32_32x32x16_bf16 v[56:71], v[24:27], v[16:19], v[56:71]
    v_mfma_f32_32x32x16_bf16 v[72:87], v[24:27], v[20:23], v[72:87]
    ds_read_b64_tr_b16 v[24:25], v6 offset:0
    ds_read_b64_tr_b16 v[26:27], v6 offset:768
    v_mfma_f32_32x32x16_bf16 v[88:103], v[28:31], v[16:19], v[88:103]
    v_mfma_f32_32x32x16_bf16 v[104:119], v[28:31], v[20:23], v[104:119]
    ds_read_b64_tr_b16 v[28:29], v6 offset:32
    ds_read_b64_tr_b16 v[30:31], v6 offset:800
    v_mfma_f32_32x32x16_bf16 v[120:135], v[32:35], v[16:19], v[120:135]
    ds_read_b128 v[16:19], v2 offset:0
    v_mfma_f32_32x32x16_bf16 v[136:151], v[32:35], v[20:23], v[136:151]
    ds_read_b128 v[20:23], v2 offset:4096
    ds_read_b64_tr_b16 v[32:33], v6 offset:64
    ds_read_b64_tr_b16 v[34:35], v6 offset:832
    s_waitcnt lgkmcnt(12)
    v_mfma_f32_32x32x16_bf16 v[56:71], v[44:47], v[36:39], v[56:71]
    s_waitcnt lgkmcnt(11)
    v_mfma_f32_32x32x16_bf16 v[72:87], v[44:47], v[40:43], v[72:87]
    ds_read_b64_tr_b16 v[44:45], v1 offset:0
    ds_read_b64_tr_b16 v[46:47], v1 offset:768
    v_mfma_f32_32x32x16_bf16 v[88:103], v[48:51], v[36:39], v[88:103]
    v_mfma_f32_32x32x16_bf16 v[104:119], v[48:51], v[40:43], v[104:119]
    ds_read_b64_tr_b16 v[48:49], v1 offset:32
    ds_read_b64_tr_b16 v[50:51], v1 offset:800
    s_waitcnt lgkmcnt(13)
    v_mfma_f32_32x32x16_bf16 v[120:135], v[52:55], v[36:39], v[120:135]
    ds_read_b128 v[36:39], v3 offset:0
    v_mfma_f32_32x32x16_bf16 v[136:151], v[52:55], v[40:43], v[136:151]
    ds_read_b128 v[40:43], v3 offset:4096
    ds_read_b64_tr_b16 v[52:53], v1 offset:64
    ds_read_b64_tr_b16 v[54:55], v1 offset:832
    s_waitcnt lgkmcnt(11)
    v_mfma_f32_32x32x16_bf16 v[56:71], v[24:27], v[16:19], v[56:71]
    s_waitcnt lgkmcnt(10)
    v_mfma_f32_32x32x16_bf16 v[72:87], v[24:27], v[20:23], v[72:87]
    ds_read_b64_tr_b16 v[24:25], v6 offset:6144
    ds_read_b64_tr_b16 v[26:27], v6 offset:6912
    v_mfma_f32_32x32x16_bf16 v[88:103], v[28:31], v[16:19], v[88:103]
    v_mfma_f32_32x32x16_bf16 v[104:119], v[28:31], v[20:23], v[104:119]
    ds_read_b64_tr_b16 v[28:29], v6 offset:6176
    ds_read_b64_tr_b16 v[30:31], v6 offset:6944
    s_waitcnt lgkmcnt(12)
    v_mfma_f32_32x32x16_bf16 v[120:135], v[32:35], v[16:19], v[120:135]
    ds_read_b128 v[16:19], v4 offset:0
    v_mfma_f32_32x32x16_bf16 v[136:151], v[32:35], v[20:23], v[136:151]
    ds_read_b128 v[20:23], v4 offset:4096
    ds_read_b64_tr_b16 v[32:33], v6 offset:6208
    ds_read_b64_tr_b16 v[34:35], v6 offset:6976
    ds_read_b32 v9, v7
    s_waitcnt lgkmcnt(12)
    v_mfma_f32_32x32x16_bf16 v[56:71], v[44:47], v[36:39], v[56:71]
    s_waitcnt lgkmcnt(11)
    v_mfma_f32_32x32x16_bf16 v[72:87], v[44:47], v[40:43], v[72:87]
    ds_read_b64_tr_b16 v[44:45], v1 offset:6144
    ds_read_b64_tr_b16 v[46:47], v1 offset:6912
    v_mfma_f32_32x32x16_bf16 v[88:103], v[48:51], v[36:39], v[88:103]
    v_mfma_f32_32x32x16_bf16 v[104:119], v[48:51], v[40:43], v[104:119]
    ds_read_b64_tr_b16 v[48:49], v1 offset:6176
    ds_read_b64_tr_b16 v[50:51], v1 offset:6944
    s_waitcnt lgkmcnt(13)
    v_mfma_f32_32x32x16_bf16 v[120:135], v[52:55], v[36:39], v[120:135]
    ds_read_b128 v[36:39], v5 offset:0
    v_mfma_f32_32x32x16_bf16 v[136:151], v[52:55], v[40:43], v[136:151]
    ds_read_b128 v[40:43], v5 offset:4096
    ds_read_b64_tr_b16 v[52:53], v1 offset:6208
    ds_read_b64_tr_b16 v[54:55], v1 offset:6976
    v_mov_b32 v10, 2
    ds_write_b32 v8, v10
    s_waitcnt lgkmcnt(9)
    v_cmp_gt_u32 vcc, 3, v9
    s_cbranch_vccnz Lst_1132
Lrt_1133:
    v_add_u32 v2, 40992, v2
    v_add_u32 v3, 40992, v3
    v_add_u32 v4, 40992, v4
    v_add_u32 v5, 40992, v5
    v_add_u32 v6, 40992, v6
    v_add_u32 v1, 40992, v1
    v_mfma_f32_32x32x16_bf16 v[56:71], v[24:27], v[16:19], v[56:71]
    v_mfma_f32_32x32x16_bf16 v[72:87], v[24:27], v[20:23], v[72:87]
    ds_read_b64_tr_b16 v[24:25], v6 offset:0
    ds_read_b64_tr_b16 v[26:27], v6 offset:768
    v_mfma_f32_32x32x16_bf16 v[88:103], v[28:31], v[16:19], v[88:103]
    v_mfma_f32_32x32x16_bf16 v[104:119], v[28:31], v[20:23], v[104:119]
    ds_read_b64_tr_b16 v[28:29], v6 offset:32
    ds_read_b64_tr_b16 v[30:31], v6 offset:800
    v_mfma_f32_32x32x16_bf16 v[120:135], v[32:35], v[16:19], v[120:135]
    ds_read_b128 v[16:19], v2 offset:0
    v_mfma_f32_32x32x16_bf16 v[136:151], v[32:35], v[20:23], v[136:151]
    ds_read_b128 v[20:23], v2 offset:4096
    ds_read_b64_tr_b16 v[32:33], v6 offset:64
    ds_read_b64_tr_b16 v[34:35], v6 offset:832
    s_waitcnt lgkmcnt(12)
    v_mfma_f32_32x32x16_bf16 v[56:71], v[44:47], v[36:39], v[56:71]
    s_waitcnt lgkmcnt(11)
    v_mfma_f32_32x32x16_bf16 v[72:87], v[44:47], v[40:43], v[72:87]
    ds_read_b64_tr_b16 v[44:45], v1 offset:0
    ds_read_b64_tr_b16 v[46:47], v1 offset:768
    v_mfma_f32_32x32x16_bf16 v[88:103], v[48:51], v[36:39], v[88:103]
    v_mfma_f32_32x32x16_bf16 v[104:119], v[48:51], v[40:43], v[104:119]
    ds_read_b64_tr_b16 v[48:49], v1 offset:32
    ds_read_b64_tr_b16 v[50:51], v1 offset:800
    s_waitcnt lgkmcnt(13)
    v_mfma_f32_32x32x16_bf16 v[120:135], v[52:55], v[36:39], v[120:135]
    ds_read_b128 v[36:39], v3 offset:0
    v_mfma_f32_32x32x16_bf16 v[136:151], v[52:55], v[40:43], v[136:151]
    ds_read_b128 v[40:43], v3 offset:4096
    ds_read_b64_tr_b16 v[52:53], v1 offset:64
    ds_read_b64_tr_b16 v[54:55], v1 offset:832
    s_waitcnt lgkmcnt(11)
    v_mfma_f32_32x32x16_bf16 v[56:71], v[24:27], v[16:19], v[56:71]
    s_waitcnt lgkmcnt(10)
    v_mfma_f32_32x32x16_bf16 v[72:87], v[24:27], v[20:23], v[72:87]
    ds_read_b64_tr_b16 v[24:25], v6 offset:6144
    ds_read_b64_tr_b16 v[26:27], v6 offset:6912
    v_mfma_f32_32x32x16_bf16 v[88:103], v[28:31], v[16:19], v[88:103]
    v_mfma_f32_32x32x16_bf16 v[104:119], v[28:31], v[20:23], v[104:119]
    ds_read_b64_tr_b16 v[28:29], v6 offset:6176
    ds_read_b64_tr_b16 v[30:31], v6 offset:6944
    s_waitcnt lgkmcnt(12)
    v_mfma_f32_32x32x16_bf16 v[120:135], v[32:35], v[16:19], v[120:135]
    ds_read_b128 v[16:19], v4 offset:0
    v_mfma_f32_32x32x16_bf16 v[136:151], v[32:35], v[20:23], v[136:151]
    ds_read_b128 v[20:23], v4 offset:4096
    ds_read_b64_tr_b16 v[32:33], v6 offset:6208
    ds_read_b64_tr_b16 v[34:35], v6 offset:6976
    ds_read_b32 v9, v7
    s_waitcnt lgkmcnt(12)
    v_mfma_f32_32x32x16_bf16 v[56:71], v[44:47], v[36:39], v[56:71]
    s_waitcnt lgkmcnt(11)
    v_mfma_f32_32x32x16_bf16 v[72:87], v[44:47], v[40:43], v[72:87]
    ds_read_b64_tr_b16 v[44:45], v1 offset:6144
    ds_read_b64_tr_b16 v[46:47], v1 offset:6912
    v_mfma_f32_32x32x16_bf16 v[88:103], v[48:51], v[36:39], v[88:103]
    v_mfma_f32_32x32x16_bf16 v[104:119], v[48:51], v[40:43], v[104:119]
    ds_read_b64_tr_b16 v[48:49], v1 offset:6176
    ds_read_b64_tr_b16 v[50:51], v1 offset:6944
    s_waitcnt lgkmcnt(13)
    v_mfma_f32_32x32x16_bf16 v[120:135], v[52:55], v[36:39], v[120:135]
    ds_read_b128 v[36:39], v5 offset:0
    v_mfma_f32_32x32x16_bf16 v[136:151], v[52:55], v[40:43], v[136:151]
    ds_read_b128 v[40:43], v5 offset:4096
    ds_read_b64_tr_b16 v[52:53], v1 offset:6208
    ds_read_b64_tr_b16 v[54:55], v1 offset:6976
    v_mov_b32 v10, 3
    ds_write_b32 v8, v10
    s_waitcnt lgkmcnt(9)
    v_cmp_gt_u32 vcc, 4, v9
    s_cbranch_vccnz Lst_1135
Lrt_1136:
    v_add_u32 v2, 4294885312, v2
    v_add_u32 v3, 4294885312, v3
    v_add_u32 v4, 4294885312, v4
    v_add_u32 v5, 4294885312, v5
    v_add_u32 v6, 4294885312, v6
    v_add_u32 v1, 4294885312, v1
    v_mfma_f32_32x32x16_bf16 v[56:71], v[24:27], v[16:19], v[56:71]
    v_mfma_f32_32x32x16_bf16 v[72:87], v[24:27], v[20:23], v[72:87]
    ds_read_b64_tr_b16 v[24:25], v6 offset:0
    ds_read_b64_tr_b16 v[26:27], v6 offset:768
    v_mfma_f32_32x32x16_bf16 v[88:103], v[28:31], v[16:19], v[88:103]
    v_mfma_f32_32x32x16_bf16 v[104:119], v[28:31], v[20:23], v[104:119]
    ds_read_b64_tr_b16 v[28:29], v6 offset:32
    ds_read_b64_tr_b16 v[30:31], v6 offset:800
    v_mfma_f32_32x32x16_bf16 v[120:135], v[32:35], v[16:19], v[120:135]
    ds_read_b128 v[16:19], v2 offset:0
    v_mfma_f32_32x32x16_bf16 v[136:151], v[32:35], v[20:23], v[136:151]
    ds_read_b128 v[20:23], v2 offset:4096
    ds_read_b64_tr_b16 v[32:33], v6 offset:64
    ds_read_b64_tr_b16 v[34:35], v6 offset:832
    s_waitcnt lgkmcnt(12)
    v_mfma_f32_32x32x16_bf16 v[56:71], v[44:47], v[36:39], v[56:71]
    s_waitcnt lgkmcnt(11)
    v_mfma_f32_32x32x16_bf16 v[72:87], v[44:47], v[40:43], v[72:87]
    ds_read_b64_tr_b16 v[44:45], v1 offset:0
    ds_read_b64_tr_b16 v[46:47], v1 offset:768
    v_mfma_f32_32x32x16_bf16 v[88:103], v[48:51], v[36:39], v[88:103]
    v_mfma_f32_32x32x16_bf16 v[104:119], v[48:51], v[40:43], v[104:119]
    ds_read_b64_tr_b16 v[48:49], v1 offset:32
    ds_read_b64_tr_b16 v[50:51], v1 offset:800
    s_waitcnt lgkmcnt(13)
    v_mfma_f32_32x32x16_bf16 v[120:135], v[52:55], v[36:39], v[120:135]
    ds_read_b128 v[36:39], v3 offset:0
    v_mfma_f32_32x32x16_bf16 v[136:151], v[52:55], v[40:43], v[136:151]
    ds_read_b128 v[40:43], v3 offset:4096
    ds_read_b64_tr_b16 v[52:53], v1 offset:64
    ds_read_b64_tr_b16 v[54:55], v1 offset:832
    s_waitcnt lgkmcnt(11)
    v_mfma_f32_32x32x16_bf16 v[56:71], v[24:27], v[16:19], v[56:71]
    s_waitcnt lgkmcnt(10)
    v_mfma_f32_32x32x16_bf16 v[72:87], v[24:27], v[20:23], v[72:87]
    ds_read_b64_tr_b16 v[24:25], v6 offset:6144
    ds_read_b64_tr_b16 v[26:27], v6 offset:6912
    v_mfma_f32_32x32x16_bf16 v[88:103], v[28:31], v[16:19], v[88:103]
    v_mfma_f32_32x32x16_bf16 v[104:119], v[28:31], v[20:23], v[104:119]
    ds_read_b64_tr_b16 v[28:29], v6 offset:6176
    ds_read_b64_tr_b16 v[30:31], v6 offset:6944
    s_waitcnt lgkmcnt(12)
    v_mfma_f32_32x32x16_bf16 v[120:135], v[32:35], v[16:19], v[120:135]
    ds_read_b128 v[16:19], v4 offset:0
    v_mfma_f32_32x32x16_bf16 v[136:151], v[32:35], v[20:23], v[136:151]
    ds_read_b128 v[20:23], v4 offset:4096
    ds_read_b64_tr_b16 v[32:33], v6 offset:6208
    ds_read_b64_tr_b16 v[34:35], v6 offset:6976
    ds_read_b32 v9, v7
    s_waitcnt lgkmcnt(12)
    v_mfma_f32_32x32x16_bf16 v[56:71], v[44:47], v[36:39], v[56:71]
    s_waitcnt lgkmcnt(11)
    v_mfma_f32_32x32x16_bf16 v[72:87], v[44:47], v[40:43], v[72:87]
    ds_read_b64_tr_b16 v[44:45], v1 offset:6144
    ds_read_b64_tr_b16 v[46:47], v1 offset:6912
    v_mfma_f32_32x32x16_bf16 v[88:103], v[48:51], v[36:39], v[88:103]
    v_mfma_f32_32x32x16_bf16 v[104:119], v[48:51], v[40:43], v[104:119]
    ds_read_b64_tr_b16 v[48:49], v1 offset:6176
    ds_read_b64_tr_b16 v[50:51], v1 offset:6944
    s_waitcnt lgkmcnt(13)
    v_mfma_f32_32x32x16_bf16 v[120:135], v[52:55], v[36:39], v[120:135]
    ds_read_b128 v[36:39], v5 offset:0
    v_mfma_f32_32x32x16_bf16 v[136:151], v[52:55], v[40:43], v[136:151]
    ds_read_b128 v[40:43], v5 offset:4096
    ds_read_b64_tr_b16 v[52:53], v1 offset:6208
    ds_read_b64_tr_b16 v[54:55], v1 offset:6976
    v_mov_b32 v10, 4
    ds_write_b32 v8, v10
    s_waitcnt lgkmcnt(9)
    v_cmp_gt_u32 vcc, 5, v9
    s_cbranch_vccnz Lst_1138
Lrt_1139:
    v_add_u32 v2, 40992, v2
    v_add_u32 v3, 40992, v3
    v_add_u32 v4, 40992, v4
    v_add_u32 v5, 40992, v5
    v_add_u32 v6, 40992, v6
    v_add_u32 v1, 40992, v1
    v_mfma_f32_32x32x16_bf16 v[56:71], v[24:27], v[16:19], v[56:71]
    v_mfma_f32_32x32x16_bf16 v[72:87], v[24:27], v[20:23], v[72:87]
    ds_read_b64_tr_b16 v[24:25], v6 offset:0
    ds_read_b64_tr_b16 v[26:27], v6 offset:768
    v_mfma_f32_32x32x16_bf16 v[88:103], v[28:31], v[16:19], v[88:103]
    v_mfma_f32_32x32x16_bf16 v[104:119], v[28:31], v[20:23], v[104:119]
    ds_read_b64_tr_b16 v[28:29], v6 offset:32
    ds_read_b64_tr_b16 v[30:31], v6 offset:800
    v_mfma_f32_32x32x16_bf16 v[120:135], v[32:35], v[16:19], v[120:135]
    ds_read_b128 v[16:19], v2 offset:0
    v_mfma_f32_32x32x16_bf16 v[136:151], v[32:35], v[20:23], v[136:151]
    ds_read_b128 v[20:23], v2 offset:4096
    ds_read_b64_tr_b16 v[32:33], v6 offset:64
    ds_read_b64_tr_b16 v[34:35], v6 offset:832
    s_waitcnt lgkmcnt(12)
    v_mfma_f32_32x32x16_bf16 v[56:71], v[44:47], v[36:39], v[56:71]
    s_waitcnt lgkmcnt(11)
    v_mfma_f32_32x32x16_bf16 v[72:87], v[44:47], v[40:43], v[72:87]
    ds_read_b64_tr_b16 v[44:45], v1 offset:0
    ds_read_b64_tr_b16 v[46:47], v1 offset:768
    v_mfma_f32_32x32x16_bf16 v[88:103], v[48:51], v[36:39], v[88:103]
    v_mfma_f32_32x32x16_bf16 v[104:119], v[48:51], v[40:43], v[104:119]
    ds_read_b64_tr_b16 v[48:49], v1 offset:32
    ds_read_b64_tr_b16 v[50:51], v1 offset:800
    s_waitcnt lgkmcnt(13)
    v_mfma_f32_32x32x16_bf16 v[120:135], v[52:55], v[36:39], v[120:135]
    ds_read_b128 v[36:39], v3 offset:0
    v_mfma_f32_32x32x16_bf16 v[136:151], v[52:55], v[40:43], v[136:151]
    ds_read_b128 v[40:43], v3 offset:4096
    ds_read_b64_tr_b16 v[52:53], v1 offset:64
    ds_read_b64_tr_b16 v[54:55], v1 offset:832
    s_waitcnt lgkmcnt(11)
    v_mfma_f32_32x32x16_bf16 v[56:71], v[24:27], v[16:19], v[56:71]
    s_waitcnt lgkmcnt(10)
    v_mfma_f32_32x32x16_bf16 v[72:87], v[24:27], v[20:23], v[72:87]
    ds_read_b64_tr_b16 v[24:25], v6 offset:6144
    ds_read_b64_tr_b16 v[26:27], v6 offset:6912
    v_mfma_f32_32x32x16_bf16 v[88:103], v[28:31], v[16:19], v[88:103]
    v_mfma_f32_32x32x16_bf16 v[104:119], v[28:31], v[20:23], v[104:119]
    ds_read_b64_tr_b16 v[28:29], v6 offset:6176
    ds_read_b64_tr_b16 v[30:31], v6 offset:6944
    s_waitcnt lgkmcnt(12)
    v_mfma_f32_32x32x16_bf16 v[120:135], v[32:35], v[16:19], v[120:135]
    ds_read_b128 v[16:19], v4 offset:0
    v_mfma_f32_32x32x16_bf16 v[136:151], v[32:35], v[20:23], v[136:151]
    ds_read_b128 v[20:23], v4 offset:4096
    ds_read_b64_tr_b16 v[32:33], v6 offset:6208
    ds_read_b64_tr_b16 v[34:35], v6 offset:6976
    ds_read_b32 v9, v7
    s_waitcnt lgkmcnt(12)
    v_mfma_f32_32x32x16_bf16 v[56:71], v[44:47], v[36:39], v[56:71]
    s_waitcnt lgkmcnt(11)
    v_mfma_f32_32x32x16_bf16 v[72:87], v[44:47], v[40:43], v[72:87]
    ds_read_b64_tr_b16 v[44:45], v1 offset:6144
    ds_read_b64_tr_b16 v[46:47], v1 offset:6912
    v_mfma_f32_32x32x16_bf16 v[88:103], v[48:51], v[36:39], v[88:103]
    v_mfma_f32_32x32x16_bf16 v[104:119], v[48:51], v[40:43], v[104:119]
    ds_read_b64_tr_b16 v[48:49], v1 offset:6176
    ds_read_b64_tr_b16 v[50:51], v1 offset:6944
    s_waitcnt lgkmcnt(13)
    v_mfma_f32_32x32x16_bf16 v[120:135], v[52:55], v[36:39], v[120:135]
    ds_read_b128 v[36:39], v5 offset:0
    v_mfma_f32_32x32x16_bf16 v[136:151], v[52:55], v[40:43], v[136:151]
    ds_read_b128 v[40:43], v5 offset:4096
    ds_read_b64_tr_b16 v[52:53], v1 offset:6208
    ds_read_b64_tr_b16 v[54:55], v1 offset:6976
    v_mov_b32 v10, 5
    ds_write_b32 v8, v10
    s_waitcnt lgkmcnt(9)
    v_cmp_gt_u32 vcc, 6, v9
    s_cbranch_vccnz Lst_1141
Lrt_1142:
    v_add_u32 v2, 40992, v2
    v_add_u32 v3, 40992, v3
    v_add_u32 v4, 40992, v4
    v_add_u32 v5, 40992, v5
    v_add_u32 v6, 40992, v6
    v_add_u32 v1, 40992, v1
    v_mfma_f32_32x32x16_bf16 v[56:71], v[24:27], v[16:19], v[56:71]
    v_mfma_f32_32x32x16_bf16 v[72:87], v[24:27], v[20:23], v[72:87]
    ds_read_b64_tr_b16 v[24:25], v6 offset:0
    ds_read_b64_tr_b16 v[26:27], v6 offset:768
    v_mfma_f32_32x32x16_bf16 v[88:103], v[28:31], v[16:19], v[88:103]
    v_mfma_f32_32x32x16_bf16 v[104:119], v[28:31], v[20:23], v[104:119]
    ds_read_b64_tr_b16 v[28:29], v6 offset:32
    ds_read_b64_tr_b16 v[30:31], v6 offset:800
    v_mfma_f32_32x32x16_bf16 v[120:135], v[32:35], v[16:19], v[120:135]
    ds_read_b128 v[16:19], v2 offset:0
    v_mfma_f32_32x32x16_bf16 v[136:151], v[32:35], v[20:23], v[136:151]
    ds_read_b128 v[20:23], v2 offset:4096
    ds_read_b64_tr_b16 v[32:33], v6 offset:64
    ds_read_b64_tr_b16 v[34:35], v6 offset:832
    s_waitcnt lgkmcnt(12)
    v_mfma_f32_32x32x16_bf16 v[56:71], v[44:47], v[36:39], v[56:71]
    s_waitcnt lgkmcnt(11)
    v_mfma_f32_32x32x16_bf16 v[72:87], v[44:47], v[40:43], v[72:87]
    ds_read_b64_tr_b16 v[44:45], v1 offset:0
    ds_read_b64_tr_b16 v[46:47], v1 offset:768
    v_mfma_f32_32x32x16_bf16 v[88:103], v[48:51], v[36:39], v[88:103]
    v_mfma_f32_32x32x16_bf16 v[104:119], v[48:51], v[40:43], v[104:119]
    ds_read_b64_tr_b16 v[48:49], v1 offset:32
    ds_read_b64_tr_b16 v[50:51], v1 offset:800
    s_waitcnt lgkmcnt(13)
    v_mfma_f32_32x32x16_bf16 v[120:135], v[52:55], v[36:39], v[120:135]
    ds_read_b128 v[36:39], v3 offset:0
    v_mfma_f32_32x32x16_bf16 v[136:151], v[52:55], v[40:43], v[136:151]
    ds_read_b128 v[40:43], v3 offset:4096
    ds_read_b64_tr_b16 v[52:53], v1 offset:64
    ds_read_b64_tr_b16 v[54:55], v1 offset:832
    s_waitcnt lgkmcnt(11)
    v_mfma_f32_32x32x16_bf16 v[56:71], v[24:27], v[16:19], v[56:71]
    s_waitcnt lgkmcnt(10)
    v_mfma_f32_32x32x16_bf16 v[72:87], v[24:27], v[20:23], v[72:87]
    ds_read_b64_tr_b16 v[24:25], v6 offset:6144
    ds_read_b64_tr_b16 v[26:27], v6 offset:6912
    v_mfma_f32_32x32x16_bf16 v[88:103], v[28:31], v[16:19], v[88:103]
    v_mfma_f32_32x32x16_bf16 v[104:119], v[28:31], v[20:23], v[104:119]
    ds_read_b64_tr_b16 v[28:29], v6 offset:6176
    ds_read_b64_tr_b16 v[30:31], v6 offset:6944
    s_waitcnt lgkmcnt(12)
    v_mfma_f32_32x32x16_bf16 v[120:135], v[32:35], v[16:19], v[120:135]
    ds_read_b128 v[16:19], v4 offset:0
    v_mfma_f32_32x32x16_bf16 v[136:151], v[32:35], v[20:23], v[136:151]
    ds_read_b128 v[20:23], v4 offset:4096
    ds_read_b64_tr_b16 v[32:33], v6 offset:6208
    ds_read_b64_tr_b16 v[34:35], v6 offset:6976
    ds_read_b32 v9, v7
    s_waitcnt lgkmcnt(12)
    v_mfma_f32_32x32x16_bf16 v[56:71], v[44:47], v[36:39], v[56:71]
    s_waitcnt lgkmcnt(11)
    v_mfma_f32_32x32x16_bf16 v[72:87], v[44:47], v[40:43], v[72:87]
    ds_read_b64_tr_b16 v[44:45], v1 offset:6144
    ds_read_b64_tr_b16 v[46:47], v1 offset:6912
    v_mfma_f32_32x32x16_bf16 v[88:103], v[48:51], v[36:39], v[88:103]
    v_mfma_f32_32x32x16_bf16 v[104:119], v[48:51], v[40:43], v[104:119]
    ds_read_b64_tr_b16 v[48:49], v1 offset:6176
    ds_read_b64_tr_b16 v[50:51], v1 offset:6944
    s_waitcnt lgkmcnt(13)
    v_mfma_f32_32x32x16_bf16 v[120:135], v[52:55], v[36:39], v[120:135]
    ds_read_b128 v[36:39], v5 offset:0
    v_mfma_f32_32x32x16_bf16 v[136:151], v[52:55], v[40:43], v[136:151]
    ds_read_b128 v[40:43], v5 offset:4096
    ds_read_b64_tr_b16 v[52:53], v1 offset:6208
    ds_read_b64_tr_b16 v[54:55], v1 offset:6976
    v_mov_b32 v10, 6
    ds_write_b32 v8, v10
    s_waitcnt lgkmcnt(9)
    v_cmp_gt_u32 vcc, 7, v9
    s_cbranch_vccnz Lst_1144
Lrt_1145:
    v_add_u32 v2, 4294885312, v2
    v_add_u32 v3, 4294885312, v3
    v_add_u32 v4, 4294885312, v4
    v_add_u32 v5, 4294885312, v5
    v_add_u32 v6, 4294885312, v6
    v_add_u32 v1, 4294885312, v1
    v_mfma_f32_32x32x16_bf16 v[56:71], v[24:27], v[16:19], v[56:71]
    v_mfma_f32_32x32x16_bf16 v[72:87], v[24:27], v[20:23], v[72:87]
    ds_read_b64_tr_b16 v[24:25], v6 offset:0
    ds_read_b64_tr_b16 v[26:27], v6 offset:768
    v_mfma_f32_32x32x16_bf16 v[88:103], v[28:31], v[16:19], v[88:103]
    v_mfma_f32_32x32x16_bf16 v[104:119], v[28:31], v[20:23], v[104:119]
    ds_read_b64_tr_b16 v[28:29], v6 offset:32
    ds_read_b64_tr_b16 v[30:31], v6 offset:800
    v_mfma_f32_32x32x16_bf16 v[120:135], v[32:35], v[16:19], v[120:135]
    ds_read_b128 v[16:19], v2 offset:0
    v_mfma_f32_32x32x16_bf16 v[136:151], v[32:35], v[20:23], v[136:151]
    ds_read_b128 v[20:23], v2 offset:4096
    ds_read_b64_tr_b16 v[32:33], v6 offset:64
    ds_read_b64_tr_b16 v[34:35], v6 offset:832
    s_waitcnt lgkmcnt(12)
    v_mfma_f32_32x32x16_bf16 v[56:71], v[44:47], v[36:39], v[56:71]
    s_waitcnt lgkmcnt(11)
    v_mfma_f32_32x32x16_bf16 v[72:87], v[44:47], v[40:43], v[72:87]
    ds_read_b64_tr_b16 v[44:45], v1 offset:0
    ds_read_b64_tr_b16 v[46:47], v1 offset:768
    v_mfma_f32_32x32x16_bf16 v[88:103], v[48:51], v[36:39], v[88:103]
    v_mfma_f32_32x32x16_bf16 v[104:119], v[48:51], v[40:43], v[104:119]
    ds_read_b64_tr_b16 v[48:49], v1 offset:32
    ds_read_b64_tr_b16 v[50:51], v1 offset:800
    s_waitcnt lgkmcnt(13)
    v_mfma_f32_32x32x16_bf16 v[120:135], v[52:55], v[36:39], v[120:135]
    ds_read_b128 v[36:39], v3 offset:0
    v_mfma_f32_32x32x16_bf16 v[136:151], v[52:55], v[40:43], v[136:151]
    ds_read_b128 v[40:43], v3 offset:4096
    ds_read_b64_tr_b16 v[52:53], v1 offset:64
    ds_read_b64_tr_b16 v[54:55], v1 offset:832
    s_waitcnt lgkmcnt(11)
    v_mfma_f32_32x32x16_bf16 v[56:71], v[24:27], v[16:19], v[56:71]
    s_waitcnt lgkmcnt(10)
    v_mfma_f32_32x32x16_bf16 v[72:87], v[24:27], v[20:23], v[72:87]
    ds_read_b64_tr_b16 v[24:25], v6 offset:6144
    ds_read_b64_tr_b16 v[26:27], v6 offset:6912
    v_mfma_f32_32x32x16_bf16 v[88:103], v[28:31], v[16:19], v[88:103]
    v_mfma_f32_32x32x16_bf16 v[104:119], v[28:31], v[20:23], v[104:119]
    ds_read_b64_tr_b16 v[28:29], v6 offset:6176
    ds_read_b64_tr_b16 v[30:31], v6 offset:6944
    s_waitcnt lgkmcnt(12)
    v_mfma_f32_32x32x16_bf16 v[120:135], v[32:35], v[16:19], v[120:135]
    ds_read_b128 v[16:19], v4 offset:0
    v_mfma_f32_32x32x16_bf16 v[136:151], v[32:35], v[20:23], v[136:151]
    ds_read_b128 v[20:23], v4 offset:4096
    ds_read_b64_tr_b16 v[32:33], v6 offset:6208
    ds_read_b64_tr_b16 v[34:35], v6 offset:6976
    ds_read_b32 v9, v7
    s_waitcnt lgkmcnt(12)
    v_mfma_f32_32x32x16_bf16 v[56:71], v[44:47], v[36:39], v[56:71]
    s_waitcnt lgkmcnt(11)
    v_mfma_f32_32x32x16_bf16 v[72:87], v[44:47], v[40:43], v[72:87]
    ds_read_b64_tr_b16 v[44:45], v1 offset:6144
    ds_read_b64_tr_b16 v[46:47], v1 offset:6912
    v_mfma_f32_32x32x16_bf16 v[88:103], v[48:51], v[36:39], v[88:103]
    v_mfma_f32_32x32x16_bf16 v[104:119], v[48:51], v[40:43], v[104:119]
    ds_read_b64_tr_b16 v[48:49], v1 offset:6176
    ds_read_b64_tr_b16 v[50:51], v1 offset:6944
    s_waitcnt lgkmcnt(13)
    v_mfma_f32_32x32x16_bf16 v[120:135], v[52:55], v[36:39], v[120:135]
    ds_read_b128 v[36:39], v5 offset:0
    v_mfma_f32_32x32x16_bf16 v[136:151], v[52:55], v[40:43], v[136:151]
    ds_read_b128 v[40:43], v5 offset:4096
    ds_read_b64_tr_b16 v[52:53], v1 offset:6208
    ds_read_b64_tr_b16 v[54:55], v1 offset:6976
    v_mov_b32 v10, 7
    ds_write_b32 v8, v10
    s_waitcnt lgkmcnt(9)
    v_cmp_gt_u32 vcc, 8, v9
    s_cbranch_vccnz Lst_1147
Lrt_1148:
    v_add_u32 v2, 40992, v2
    v_add_u32 v3, 40992, v3
    v_add_u32 v4, 40992, v4
    v_add_u32 v5, 40992, v5
    v_add_u32 v6, 40992, v6
    v_add_u32 v1, 40992, v1
    v_mfma_f32_32x32x16_bf16 v[56:71], v[24:27], v[16:19], v[56:71]
    v_mfma_f32_32x32x16_bf16 v[72:87], v[24:27], v[20:23], v[72:87]
    ds_read_b64_tr_b16 v[24:25], v6 offset:0
    ds_read_b64_tr_b16 v[26:27], v6 offset:768
    v_mfma_f32_32x32x16_bf16 v[88:103], v[28:31], v[16:19], v[88:103]
    v_mfma_f32_32x32x16_bf16 v[104:119], v[28:31], v[20:23], v[104:119]
    ds_read_b64_tr_b16 v[28:29], v6 offset:32
    ds_read_b64_tr_b16 v[30:31], v6 offset:800
    v_mfma_f32_32x32x16_bf16 v[120:135], v[32:35], v[16:19], v[120:135]
    ds_read_b128 v[16:19], v2 offset:0
    v_mfma_f32_32x32x16_bf16 v[136:151], v[32:35], v[20:23], v[136:151]
    ds_read_b128 v[20:23], v2 offset:4096
    ds_read_b64_tr_b16 v[32:33], v6 offset:64
    ds_read_b64_tr_b16 v[34:35], v6 offset:832
    s_waitcnt lgkmcnt(12)
    v_mfma_f32_32x32x16_bf16 v[56:71], v[44:47], v[36:39], v[56:71]
    s_waitcnt lgkmcnt(11)
    v_mfma_f32_32x32x16_bf16 v[72:87], v[44:47], v[40:43], v[72:87]
    ds_read_b64_tr_b16 v[44:45], v1 offset:0
    ds_read_b64_tr_b16 v[46:47], v1 offset:768
    v_mfma_f32_32x32x16_bf16 v[88:103], v[48:51], v[36:39], v[88:103]
    v_mfma_f32_32x32x16_bf16 v[104:119], v[48:51], v[40:43], v[104:119]
    ds_read_b64_tr_b16 v[48:49], v1 offset:32
    ds_read_b64_tr_b16 v[50:51], v1 offset:800
    s_waitcnt lgkmcnt(13)
    v_mfma_f32_32x32x16_bf16 v[120:135], v[52:55], v[36:39], v[120:135]
    ds_read_b128 v[36:39], v3 offset:0
    v_mfma_f32_32x32x16_bf16 v[136:151], v[52:55], v[40:43], v[136:151]
    ds_read_b128 v[40:43], v3 offset:4096
    ds_read_b64_tr_b16 v[52:53], v1 offset:64
    ds_read_b64_tr_b16 v[54:55], v1 offset:832
    s_waitcnt lgkmcnt(11)
    v_mfma_f32_32x32x16_bf16 v[56:71], v[24:27], v[16:19], v[56:71]
    s_waitcnt lgkmcnt(10)
    v_mfma_f32_32x32x16_bf16 v[72:87], v[24:27], v[20:23], v[72:87]
    ds_read_b64_tr_b16 v[24:25], v6 offset:6144
    ds_read_b64_tr_b16 v[26:27], v6 offset:6912
    v_mfma_f32_32x32x16_bf16 v[88:103], v[28:31], v[16:19], v[88:103]
    v_mfma_f32_32x32x16_bf16 v[104:119], v[28:31], v[20:23], v[104:119]
    ds_read_b64_tr_b16 v[28:29], v6 offset:6176
    ds_read_b64_tr_b16 v[30:31], v6 offset:6944
    s_waitcnt lgkmcnt(12)
    v_mfma_f32_32x32x16_bf16 v[120:135], v[32:35], v[16:19], v[120:135]
    ds_read_b128 v[16:19], v4 offset:0
    v_mfma_f32_32x32x16_bf16 v[136:151], v[32:35], v[20:23], v[136:151]
    ds_read_b128 v[20:23], v4 offset:4096
    ds_read_b64_tr_b16 v[32:33], v6 offset:6208
    ds_read_b64_tr_b16 v[34:35], v6 offset:6976
    s_waitcnt lgkmcnt(11)
    v_mfma_f32_32x32x16_bf16 v[56:71], v[44:47], v[36:39], v[56:71]
    s_waitcnt lgkmcnt(10)
    v_mfma_f32_32x32x16_bf16 v[72:87], v[44:47], v[40:43], v[72:87]
    ds_read_b64_tr_b16 v[44:45], v1 offset:6144
    ds_read_b64_tr_b16 v[46:47], v1 offset:6912
    v_mfma_f32_32x32x16_bf16 v[88:103], v[48:51], v[36:39], v[88:103]
    v_mfma_f32_32x32x16_bf16 v[104:119], v[48:51], v[40:43], v[104:119]
    ds_read_b64_tr_b16 v[48:49], v1 offset:6176
    ds_read_b64_tr_b16 v[50:51], v1 offset:6944
    s_waitcnt lgkmcnt(12)
    v_mfma_f32_32x32x16_bf16 v[120:135], v[52:55], v[36:39], v[120:135]
    ds_read_b128 v[36:39], v5 offset:0
    v_mfma_f32_32x32x16_bf16 v[136:151], v[52:55], v[40:43], v[136:151]
    ds_read_b128 v[40:43], v5 offset:4096
    ds_read_b64_tr_b16 v[52:53], v1 offset:6208
    ds_read_b64_tr_b16 v[54:55], v1 offset:6976
    v_mov_b32 v10, 8
    ds_write_b32 v8, v10
    ds_read_b32 v9, v15
    s_waitcnt lgkmcnt(13)
    v_mfma_f32_32x32x16_bf16 v[56:71], v[24:27], v[16:19], v[56:71]
    s_waitcnt lgkmcnt(12)
    v_mfma_f32_32x32x16_bf16 v[72:87], v[24:27], v[20:23], v[72:87]
    v_mfma_f32_32x32x16_bf16 v[88:103], v[28:31], v[16:19], v[88:103]
    v_mfma_f32_32x32x16_bf16 v[104:119], v[28:31], v[20:23], v[104:119]
    s_waitcnt lgkmcnt(10)
    v_mfma_f32_32x32x16_bf16 v[120:135], v[32:35], v[16:19], v[120:135]
    v_mfma_f32_32x32x16_bf16 v[136:151], v[32:35], v[20:23], v[136:151]
    s_waitcnt lgkmcnt(0)
    v_cmp_gt_u32 vcc, 1, v9
    s_cbranch_vccnz Lst_1150
Lrt_1151:
    v_and_b32 v10, 31, v0
    v_lshlrev_b32 v10, 4, v10
    s_lshl_b32 s47, s52, 10
    s_add_u32 s47, s47, 156512
    v_add_u32 v10, s47, v10
    ds_read_b128 v[16:19], v10 offset:0
    ds_read_b128 v[20:23], v10 offset:512
    ds_read_b32 v152, v13 offset:0
    ds_read_b32 v153, v12 offset:0
    ds_read_b32 v156, v13 offset:256
    ds_read_b32 v157, v12 offset:256
    ds_read_b32 v160, v13 offset:512
    ds_read_b32 v161, v12 offset:512
    v_lshlrev_b32 v11, 4, v0
    v_lshlrev_b32 v13, 8, v0
    v_mov_b32 v12, 1
    v_mfma_f32_32x32x16_bf16 v[56:71], v[44:47], v[36:39], v[56:71]
    v_mfma_f32_32x32x16_bf16 v[72:87], v[44:47], v[40:43], v[72:87]
    v_mfma_f32_32x32x16_bf16 v[88:103], v[48:51], v[36:39], v[88:103]
    v_mfma_f32_32x32x16_bf16 v[104:119], v[48:51], v[40:43], v[104:119]
    v_mfma_f32_32x32x16_bf16 v[120:135], v[52:55], v[36:39], v[120:135]
    v_mfma_f32_32x32x16_bf16 v[136:151], v[52:55], v[40:43], v[136:151]
    s_waitcnt lgkmcnt(4)
    v_mfma_f32_32x32x16_bf16 v[56:71], v[152:155], v[16:19], v[56:71]
    v_mfma_f32_32x32x16_bf16 v[72:87], v[152:155], v[20:23], v[72:87]
    s_waitcnt lgkmcnt(2)
    v_mfma_f32_32x32x16_bf16 v[88:103], v[156:159], v[16:19], v[88:103]
    v_mfma_f32_32x32x16_bf16 v[104:119], v[156:159], v[20:23], v[104:119]
    s_waitcnt lgkmcnt(0)
    v_mfma_f32_32x32x16_bf16 v[120:135], v[160:163], v[16:19], v[120:135]
    v_mfma_f32_32x32x16_bf16 v[136:151], v[160:163], v[20:23], v[136:151]
    s_cmp_lt_u32 s56, 86
    s_cselect_b32 s58, s54, 0x7f000000
    s_add_u32 s59, s58, 88064
    s_nop 1
    v_pk_mul_f32 v[64:65], v[56:57], v[64:65]
    v_pk_mul_f32 v[66:67], v[58:59], v[66:67]
    v_pk_mul_f32 v[68:69], v[60:61], v[68:69]
    v_pk_mul_f32 v[70:71], v[62:63], v[70:71]
    v_pk_mul_f32 v[56:57], v[56:57], v[18:19] op_sel_hi:[1,0]
    v_pk_mul_f32 v[58:59], v[58:59], v[18:19] op_sel_hi:[1,0]
    v_pk_mul_f32 v[60:61], v[60:61], v[18:19] op_sel_hi:[1,0]
    v_pk_mul_f32 v[62:63], v[62:63], v[18:19] op_sel_hi:[1,0]
    v_exp_f32 v56, v56
    v_exp_f32 v57, v57
    v_exp_f32 v58, v58
    v_exp_f32 v59, v59
    v_exp_f32 v60, v60
    v_exp_f32 v61, v61
    v_exp_f32 v62, v62
    v_exp_f32 v63, v63
    v_pk_fma_f32 v[56:57], v[56:57], v[18:19], v[18:19] op_sel:[0,1,1] op_sel_hi:[1,1,1]
    v_pk_fma_f32 v[58:59], v[58:59], v[18:19], v[18:19] op_sel:[0,1,1] op_sel_hi:[1,1,1]
    v_pk_fma_f32 v[60:61], v[60:61], v[18:19], v[18:19] op_sel:[0,1,1] op_sel_hi:[1,1,1]
    v_pk_fma_f32 v[62:63], v[62:63], v[18:19], v[18:19] op_sel:[0,1,1] op_sel_hi:[1,1,1]
    v_rcp_f32 v56, v56
    v_rcp_f32 v57, v57
    v_rcp_f32 v58, v58
    v_rcp_f32 v59, v59
    v_rcp_f32 v60, v60
    v_rcp_f32 v61, v61
    v_rcp_f32 v62, v62
    v_rcp_f32 v63, v63
    v_pk_mul_f32 v[64:65], v[64:65], v[56:57]
    v_pk_mul_f32 v[66:67], v[66:67], v[58:59]
    v_pk_mul_f32 v[68:69], v[68:69], v[60:61]
    v_pk_mul_f32 v[70:71], v[70:71], v[62:63]
    v_cvt_pk_bf16_f32 v56, v64, v65
    v_cvt_pk_bf16_f32 v57, v66, v67
    v_cvt_pk_bf16_f32 v58, v68, v69
    v_cvt_pk_bf16_f32 v59, v70, v71
    buffer_store_dwordx4 v[56:59], v11, s[20:23], s58 offen offset:0 sc1
    v_pk_mul_f32 v[80:81], v[72:73], v[80:81]
    v_pk_mul_f32 v[82:83], v[74:75], v[82:83]
    v_pk_mul_f32 v[84:85], v[76:77], v[84:85]
    v_pk_mul_f32 v[86:87], v[78:79], v[86:87]
    v_pk_mul_f32 v[72:73], v[72:73], v[22:23] op_sel_hi:[1,0]
    v_pk_mul_f32 v[74:75], v[74:75], v[22:23] op_sel_hi:[1,0]
    v_pk_mul_f32 v[76:77], v[76:77], v[22:23] op_sel_hi:[1,0]
    v_pk_mul_f32 v[78:79], v[78:79], v[22:23] op_sel_hi:[1,0]
    v_exp_f32 v72, v72
    v_exp_f32 v73, v73
    v_exp_f32 v74, v74
    v_exp_f32 v75, v75
    v_exp_f32 v76, v76
    v_exp_f32 v77, v77
    v_exp_f32 v78, v78
    v_exp_f32 v79, v79
    v_pk_fma_f32 v[72:73], v[72:73], v[22:23], v[22:23] op_sel:[0,1,1] op_sel_hi:[1,1,1]
    v_pk_fma_f32 v[74:75], v[74:75], v[22:23], v[22:23] op_sel:[0,1,1] op_sel_hi:[1,1,1]
    v_pk_fma_f32 v[76:77], v[76:77], v[22:23], v[22:23] op_sel:[0,1,1] op_sel_hi:[1,1,1]
    v_pk_fma_f32 v[78:79], v[78:79], v[22:23], v[22:23] op_sel:[0,1,1] op_sel_hi:[1,1,1]
    v_rcp_f32 v72, v72
    v_rcp_f32 v73, v73
    v_rcp_f32 v74, v74
    v_rcp_f32 v75, v75
    v_rcp_f32 v76, v76
    v_rcp_f32 v77, v77
    v_rcp_f32 v78, v78
    v_rcp_f32 v79, v79
    v_pk_mul_f32 v[80:81], v[80:81], v[72:73]
    v_pk_mul_f32 v[82:83], v[82:83], v[74:75]
    v_pk_mul_f32 v[84:85], v[84:85], v[76:77]
    v_pk_mul_f32 v[86:87], v[86:87], v[78:79]
    v_cvt_pk_bf16_f32 v72, v80, v81
    v_cvt_pk_bf16_f32 v73, v82, v83
    v_cvt_pk_bf16_f32 v74, v84, v85
    v_cvt_pk_bf16_f32 v75, v86, v87
    buffer_store_dwordx4 v[72:75], v11, s[20:23], s59 offen offset:0 sc1
    s_cmp_lt_u32 s56, 85
    s_cselect_b32 s58, s54, 0x7f000000
    s_add_u32 s59, s58, 88064
    v_pk_mul_f32 v[96:97], v[88:89], v[96:97]
    v_pk_mul_f32 v[98:99], v[90:91], v[98:99]
    v_pk_mul_f32 v[100:101], v[92:93], v[100:101]
    v_pk_mul_f32 v[102:103], v[94:95], v[102:103]
    v_pk_mul_f32 v[88:89], v[88:89], v[18:19] op_sel_hi:[1,0]
    v_pk_mul_f32 v[90:91], v[90:91], v[18:19] op_sel_hi:[1,0]
    v_pk_mul_f32 v[92:93], v[92:93], v[18:19] op_sel_hi:[1,0]
    v_pk_mul_f32 v[94:95], v[94:95], v[18:19] op_sel_hi:[1,0]
    v_exp_f32 v88, v88
    v_exp_f32 v89, v89
    v_exp_f32 v90, v90
    v_exp_f32 v91, v91
    v_exp_f32 v92, v92
    v_exp_f32 v93, v93
    v_exp_f32 v94, v94
    v_exp_f32 v95, v95
    v_pk_fma_f32 v[88:89], v[88:89], v[18:19], v[18:19] op_sel:[0,1,1] op_sel_hi:[1,1,1]
    v_pk_fma_f32 v[90:91], v[90:91], v[18:19], v[18:19] op_sel:[0,1,1] op_sel_hi:[1,1,1]
    v_pk_fma_f32 v[92:93], v[92:93], v[18:19], v[18:19] op_sel:[0,1,1] op_sel_hi:[1,1,1]
    v_pk_fma_f32 v[94:95], v[94:95], v[18:19], v[18:19] op_sel:[0,1,1] op_sel_hi:[1,1,1]
    v_rcp_f32 v88, v88
    v_rcp_f32 v89, v89
    v_rcp_f32 v90, v90
    v_rcp_f32 v91, v91
    v_rcp_f32 v92, v92
    v_rcp_f32 v93, v93
    v_rcp_f32 v94, v94
    v_rcp_f32 v95, v95
    v_pk_mul_f32 v[96:97], v[96:97], v[88:89]
    v_pk_mul_f32 v[98:99], v[98:99], v[90:91]
    v_pk_mul_f32 v[100:101], v[100:101], v[92:93]
    v_pk_mul_f32 v[102:103], v[102:103], v[94:95]
    v_cvt_pk_bf16_f32 v88, v96, v97
    v_cvt_pk_bf16_f32 v89, v98, v99
    v_cvt_pk_bf16_f32 v90, v100, v101
    v_cvt_pk_bf16_f32 v91, v102, v103
    buffer_store_dwordx4 v[88:91], v11, s[20:23], s58 offen offset:1024 sc1
    v_pk_mul_f32 v[112:113], v[104:105], v[112:113]
    v_pk_mul_f32 v[114:115], v[106:107], v[114:115]
    v_pk_mul_f32 v[116:117], v[108:109], v[116:117]
    v_pk_mul_f32 v[118:119], v[110:111], v[118:119]
    v_pk_mul_f32 v[104:105], v[104:105], v[22:23] op_sel_hi:[1,0]
    v_pk_mul_f32 v[106:107], v[106:107], v[22:23] op_sel_hi:[1,0]
    v_pk_mul_f32 v[108:109], v[108:109], v[22:23] op_sel_hi:[1,0]
    v_pk_mul_f32 v[110:111], v[110:111], v[22:23] op_sel_hi:[1,0]
    v_exp_f32 v104, v104
    v_exp_f32 v105, v105
    v_exp_f32 v106, v106
    v_exp_f32 v107, v107
    v_exp_f32 v108, v108
    v_exp_f32 v109, v109
    v_exp_f32 v110, v110
    v_exp_f32 v111, v111
    v_pk_fma_f32 v[104:105], v[104:105], v[22:23], v[22:23] op_sel:[0,1,1] op_sel_hi:[1,1,1]
    v_pk_fma_f32 v[106:107], v[106:107], v[22:23], v[22:23] op_sel:[0,1,1] op_sel_hi:[1,1,1]
    v_pk_fma_f32 v[108:109], v[108:109], v[22:23], v[22:23] op_sel:[0,1,1] op_sel_hi:[1,1,1]
    v_pk_fma_f32 v[110:111], v[110:111], v[22:23], v[22:23] op_sel:[0,1,1] op_sel_hi:[1,1,1]
    v_rcp_f32 v104, v104
    v_rcp_f32 v105, v105
    v_rcp_f32 v106, v106
    v_rcp_f32 v107, v107
    v_rcp_f32 v108, v108
    v_rcp_f32 v109, v109
    v_rcp_f32 v110, v110
    v_rcp_f32 v111, v111
    v_pk_mul_f32 v[112:113], v[112:113], v[104:105]
    v_pk_mul_f32 v[114:115], v[114:115], v[106:107]
    v_pk_mul_f32 v[116:117], v[116:117], v[108:109]
    v_pk_mul_f32 v[118:119], v[118:119], v[110:111]
    v_cvt_pk_bf16_f32 v104, v112, v113
    v_cvt_pk_bf16_f32 v105, v114, v115
    v_cvt_pk_bf16_f32 v106, v116, v117
    v_cvt_pk_bf16_f32 v107, v118, v119
    buffer_store_dwordx4 v[104:107], v11, s[20:23], s59 offen offset:1024 sc1
    s_waitcnt vmcnt(2)
    s_mov_b64 exec, 3
    buffer_atomic_add v12, v13, s[20:23], s62 offen offset:0 sc1
    s_mov_b64 exec, -1
    ds_write_b32 v14, v12 offset:48
    s_cmp_lt_u32 s56, 84
    s_cselect_b32 s58, s54, 0x7f000000
    s_add_u32 s59, s58, 88064
    v_pk_mul_f32 v[128:129], v[120:121], v[128:129]
    v_pk_mul_f32 v[130:131], v[122:123], v[130:131]
    v_pk_mul_f32 v[132:133], v[124:125], v[132:133]
    v_pk_mul_f32 v[134:135], v[126:127], v[134:135]
    v_pk_mul_f32 v[120:121], v[120:121], v[18:19] op_sel_hi:[1,0]
    v_pk_mul_f32 v[122:123], v[122:123], v[18:19] op_sel_hi:[1,0]
    v_pk_mul_f32 v[124:125], v[124:125], v[18:19] op_sel_hi:[1,0]
    v_pk_mul_f32 v[126:127], v[126:127], v[18:19] op_sel_hi:[1,0]
    v_exp_f32 v120, v120
    v_exp_f32 v121, v121
    v_exp_f32 v122, v122
    v_exp_f32 v123, v123
    v_exp_f32 v124, v124
    v_exp_f32 v125, v125
    v_exp_f32 v126, v126
    v_exp_f32 v127, v127
    v_pk_fma_f32 v[120:121], v[120:121], v[18:19], v[18:19] op_sel:[0,1,1] op_sel_hi:[1,1,1]
    v_pk_fma_f32 v[122:123], v[122:123], v[18:19], v[18:19] op_sel:[0,1,1] op_sel_hi:[1,1,1]
    v_pk_fma_f32 v[124:125], v[124:125], v[18:19], v[18:19] op_sel:[0,1,1] op_sel_hi:[1,1,1]
    v_pk_fma_f32 v[126:127], v[126:127], v[18:19], v[18:19] op_sel:[0,1,1] op_sel_hi:[1,1,1]
    v_rcp_f32 v120, v120
    v_rcp_f32 v121, v121
    v_rcp_f32 v122, v122
    v_rcp_f32 v123, v123
    v_rcp_f32 v124, v124
    v_rcp_f32 v125, v125
    v_rcp_f32 v126, v126
    v_rcp_f32 v127, v127
    v_pk_mul_f32 v[128:129], v[128:129], v[120:121]
    v_pk_mul_f32 v[130:131], v[130:131], v[122:123]
    v_pk_mul_f32 v[132:133], v[132:133], v[124:125]
    v_pk_mul_f32 v[134:135], v[134:135], v[126:127]
    v_cvt_pk_bf16_f32 v120, v128, v129
    v_cvt_pk_bf16_f32 v121, v130, v131
    v_cvt_pk_bf16_f32 v122, v132, v133
    v_cvt_pk_bf16_f32 v123, v134, v135
    buffer_store_dwordx4 v[120:123], v11, s[20:23], s58 offen offset:2048 sc1
    v_pk_mul_f32 v[144:145], v[136:137], v[144:145]
    v_pk_mul_f32 v[146:147], v[138:139], v[146:147]
    v_pk_mul_f32 v[148:149], v[140:141], v[148:149]
    v_pk_mul_f32 v[150:151], v[142:143], v[150:151]
    v_pk_mul_f32 v[136:137], v[136:137], v[22:23] op_sel_hi:[1,0]
    v_pk_mul_f32 v[138:139], v[138:139], v[22:23] op_sel_hi:[1,0]
    v_pk_mul_f32 v[140:141], v[140:141], v[22:23] op_sel_hi:[1,0]
    v_pk_mul_f32 v[142:143], v[142:143], v[22:23] op_sel_hi:[1,0]
    v_exp_f32 v136, v136
    v_exp_f32 v137, v137
    v_exp_f32 v138, v138
    v_exp_f32 v139, v139
    v_exp_f32 v140, v140
    v_exp_f32 v141, v141
    v_exp_f32 v142, v142
    v_exp_f32 v143, v143
    v_pk_fma_f32 v[136:137], v[136:137], v[22:23], v[22:23] op_sel:[0,1,1] op_sel_hi:[1,1,1]
    v_pk_fma_f32 v[138:139], v[138:139], v[22:23], v[22:23] op_sel:[0,1,1] op_sel_hi:[1,1,1]
    v_pk_fma_f32 v[140:141], v[140:141], v[22:23], v[22:23] op_sel:[0,1,1] op_sel_hi:[1,1,1]
    v_pk_fma_f32 v[142:143], v[142:143], v[22:23], v[22:23] op_sel:[0,1,1] op_sel_hi:[1,1,1]
    v_rcp_f32 v136, v136
    v_rcp_f32 v137, v137
    v_rcp_f32 v138, v138
    v_rcp_f32 v139, v139
    v_rcp_f32 v140, v140
    v_rcp_f32 v141, v141
    v_rcp_f32 v142, v142
    v_rcp_f32 v143, v143
    v_pk_mul_f32 v[144:145], v[144:145], v[136:137]
    v_pk_mul_f32 v[146:147], v[146:147], v[138:139]
    v_pk_mul_f32 v[148:149], v[148:149], v[140:141]
    v_pk_mul_f32 v[150:151], v[150:151], v[142:143]
    v_cvt_pk_bf16_f32 v136, v144, v145
    v_cvt_pk_bf16_f32 v137, v146, v147
    v_cvt_pk_bf16_f32 v138, v148, v149
    v_cvt_pk_bf16_f32 v139, v150, v151
    buffer_store_dwordx4 v[136:139], v11, s[20:23], s59 offen offset:2048 sc1
    s_waitcnt vmcnt(3)
    s_mov_b64 exec, 3
    buffer_atomic_add v12, v13, s[20:23], s62 offen offset:512 sc1
    s_mov_b64 exec, -1
    s_waitcnt lgkmcnt(0)
Lcjoin_1119:
    s_nop 1
    s_and_b32 s47, s43, 3
    s_lshl2_add_u32 s50, s42, s47
    s_lshr_b32 s51, s43, 2
    s_mov_b32 s20, s82
    s_mov_b32 s21, s83
    s_mov_b32 s22, 16777216
    s_mov_b32 s23, 0x00020000
    s_mov_b32 s8, s78
    s_mov_b32 s9, s79
    s_mov_b32 s10, 2097152
    s_mov_b32 s11, 0x00020000
    s_lshr_b32 s52, s41, 1
    s_and_b32 s53, s41, 1
    s_lshl_b32 s47, s53, 2
    s_add_u32 s47, s47, 156416
    v_mov_b32 v14, s47
    s_lshl1_add_u32 s54, s50, s52
    s_mul_i32 s55, s54, 88064
    s_mul_i32 s47, s53, 3072
    s_add_u32 s55, s55, s47
    v_lshlrev_b32 v15, 4, v0
    v_add_u32 v15, s55, v15
    v_lshrrev_b32 v10, 5, v0
    v_bfe_u32 v11, v0, 2, 2
    v_lshl_add_u32 v10, v10, 3, v11
    v_lshlrev_b32 v10, 7, v10
    v_bfe_u32 v11, v0, 3, 1
    v_xor_b32 v11, s53, v11
    v_lshl_add_u32 v10, v11, 6, v10
    v_and_b32 v11, 1, v0
    v_lshl_add_u32 v10, v11, 5, v10
    v_bfe_u32 v11, v0, 4, 1
    v_lshl_add_u32 v10, v11, 4, v10
    v_bfe_u32 v11, v0, 1, 1
    v_lshl_add_u32 v10, v11, 3, v10
    v_xor_b32 v11, 64, v10
    s_mul_i32 s47, s53, 10240
    s_add_u32 s48, s47, 0
    v_add_u32 v1, s48, v10
    v_add_u32 v2, s48, v11
    s_add_u32 s48, s47, 40992
    v_add_u32 v3, s48, v10
    v_add_u32 v4, s48, v11
    s_add_u32 s48, s47, 81984
    v_add_u32 v5, s48, v10
    v_add_u32 v6, s48, v11
    s_lshl_b32 s47, s53, 2
    s_add_u32 s47, s47, 156256
    v_mov_b32 v7, s47
    s_mul_i32 s56, s53, 0x7f000000
    s_and_b32 s58, s43, 3
    s_lshl_b32 s58, s58, 1
    s_xor_b32 s58, s58, s51
    s_lshl_b32 s58, s58, 1
    s_and_b32 s47, s42, 1
    s_add_u32 s58, s58, s47
    s_min_u32 s58, s58, 13
    s_mul_i32 s58, s58, 6144
    s_sub_u32 s59, s58, 86016
    s_mov_b32 s12, s64
    s_mov_b32 s13, s65
    s_mov_b32 s14, 2097152
    s_mov_b32 s15, 0x00020000
    v_and_b32 v11, 31, v0
    v_lshlrev_b32 v11, 16, v11
    v_lshrrev_b32 v10, 5, v0
    v_lshl_add_u32 v11, v10, 5, v11
    s_lshl_b32 s61, s54, 10
    s_lshl_b32 s48, s51, 7
    s_add_u32 s61, s61, s48
    s_lshl_b32 s48, s53, 6
    s_add_u32 s61, s61, s48
    s_sub_u32 s61, s61, s48
    s_add_u32 s60, s61, 524288
    v_lshrrev_b32 v10, 3, v0
    s_lshl_b32 s47, s53, 4
    v_add_u32 v10, s47, v10
    v_lshlrev_b32 v11, 16, v10
    v_and_b32 v10, 7, v0
    v_lshl_add_u32 v11, v10, 4, v11
    s_cmp_ge_u32 s58, 86016
    s_cselect_b32 s64, s59, s58
    s_add_u32 s64, s64, 0
    s_cmp_ge_u32 s58, 79872
    s_cselect_b32 s65, s59, s58
    s_add_u32 s65, s65, 6144
    s_cmp_ge_u32 s58, 73728
    s_cselect_b32 s66, s59, s58
    s_add_u32 s66, s66, 12288
    s_cmp_ge_u32 s58, 67584
    s_cselect_b32 s67, s59, s58
    s_add_u32 s67, s67, 18432
    s_cmp_ge_u32 s58, 61440
    s_cselect_b32 s68, s59, s58
    s_add_u32 s68, s68, 24576
    s_cmp_ge_u32 s58, 55296
    s_cselect_b32 s69, s59, s58
    s_add_u32 s69, s69, 30720
    s_cmp_ge_u32 s58, 49152
    s_cselect_b32 s70, s59, s58
    s_add_u32 s70, s70, 36864
    s_cmp_ge_u32 s58, 43008
    s_cselect_b32 s71, s59, s58
    s_add_u32 s71, s71, 43008
    s_cmp_ge_u32 s58, 36864
    s_cselect_b32 s72, s59, s58
    s_add_u32 s72, s72, 49152
    s_cmp_ge_u32 s58, 30720
    s_cselect_b32 s73, s59, s58
    s_add_u32 s73, s73, 55296
    s_cmp_ge_u32 s58, 24576
    s_cselect_b32 s74, s59, s58
    s_add_u32 s74, s74, 61440
    s_cmp_ge_u32 s58, 18432
    s_cselect_b32 s75, s59, s58
    s_add_u32 s75, s75, 67584
    s_cmp_ge_u32 s58, 12288
    s_cselect_b32 s76, s59, s58
    s_add_u32 s76, s76, 73728
    s_cmp_ge_u32 s58, 6144
    s_cselect_b32 s77, s59, s58
    s_add_u32 s77, s77, 79872
    s_add_u32 s78, s56, 86016
    ds_read_b32 v9, v7
    s_waitcnt lgkmcnt(0)
    v_cmp_gt_u32 vcc, 9, v9
    s_cbranch_vccnz Lst_1153
Lrt_1154:
    ds_read_b64_tr_b16 v[48:49], v5 offset:0
    ds_read_b64_tr_b16 v[50:51], v5 offset:512
    ds_read_b64_tr_b16 v[52:53], v6 offset:0
    ds_read_b64_tr_b16 v[54:55], v6 offset:512
    ds_read_b64_tr_b16 v[56:57], v5 offset:2048
    ds_read_b64_tr_b16 v[58:59], v5 offset:2560
    ds_read_b64_tr_b16 v[60:61], v6 offset:2048
    ds_read_b64_tr_b16 v[62:63], v6 offset:2560
    ds_read_b64_tr_b16 v[64:65], v5 offset:4096
    ds_read_b64_tr_b16 v[66:67], v5 offset:4608
    ds_read_b64_tr_b16 v[68:69], v6 offset:4096
    ds_read_b64_tr_b16 v[70:71], v6 offset:4608
    ds_read_b64_tr_b16 v[72:73], v5 offset:6144
    ds_read_b64_tr_b16 v[74:75], v5 offset:6656
    ds_read_b64_tr_b16 v[76:77], v6 offset:6144
    ds_read_b64_tr_b16 v[78:79], v6 offset:6656
    ds_read_b64_tr_b16 v[80:81], v5 offset:8192
    ds_read_b64_tr_b16 v[82:83], v5 offset:8704
    ds_read_b64_tr_b16 v[84:85], v6 offset:8192
    ds_read_b64_tr_b16 v[86:87], v6 offset:8704
    v_mov_b32 v10, 9
    ds_write_b32 v8, v10
    ds_read_b32 v9, v7
    s_waitcnt lgkmcnt(0)
    v_cmp_gt_u32 vcc, 10, v9
    s_cbranch_vccnz Lst_1156
Lrt_1157:
    ds_read_b64_tr_b16 v[88:89], v5 offset:20480
    ds_read_b64_tr_b16 v[90:91], v5 offset:20992
    ds_read_b64_tr_b16 v[92:93], v6 offset:20480
    ds_read_b64_tr_b16 v[94:95], v6 offset:20992
    ds_read_b64_tr_b16 v[96:97], v5 offset:22528
    ds_read_b64_tr_b16 v[98:99], v5 offset:23040
    ds_read_b64_tr_b16 v[100:101], v6 offset:22528
    ds_read_b64_tr_b16 v[102:103], v6 offset:23040
    ds_read_b64_tr_b16 v[104:105], v5 offset:24576
    ds_read_b64_tr_b16 v[106:107], v5 offset:25088
    ds_read_b64_tr_b16 v[108:109], v6 offset:24576
    ds_read_b64_tr_b16 v[110:111], v6 offset:25088
    ds_read_b64_tr_b16 v[112:113], v5 offset:26624
    ds_read_b64_tr_b16 v[114:115], v5 offset:27136
    ds_read_b64_tr_b16 v[116:117], v6 offset:26624
    ds_read_b64_tr_b16 v[118:119], v6 offset:27136
    ds_read_b64_tr_b16 v[120:121], v5 offset:28672
    ds_read_b64_tr_b16 v[122:123], v5 offset:29184
    ds_read_b64_tr_b16 v[124:125], v6 offset:28672
    ds_read_b64_tr_b16 v[126:127], v6 offset:29184
    v_mov_b32 v10, 10
    ds_write_b32 v8, v10
    s_waitcnt vmcnt(1)
    s_mov_b64 exec, 3
    buffer_atomic_add v12, v13, s[20:23], s62 offen offset:1024 sc1
    s_mov_b64 exec, -1
    ds_read_b32 v9, v14
    s_waitcnt lgkmcnt(0)
    v_cmp_gt_u32 vcc, 1, v9
    s_cbranch_vccnz Lst_1159
Lrt_1160:
    ds_read_b32 v9, v7
    buffer_load_dwordx4 v[128:131], v15, s[20:23], s64 offen offset:0 sc1
    buffer_load_dwordx4 v[132:135], v15, s[20:23], s65 offen offset:0 sc1
    buffer_load_dwordx4 v[136:139], v15, s[20:23], s66 offen offset:0 sc1
    buffer_load_dwordx4 v[140:143], v15, s[20:23], s67 offen offset:0 sc1
    buffer_load_dwordx4 v[144:147], v15, s[20:23], s68 offen offset:0 sc1
    buffer_load_dwordx4 v[148:151], v15, s[20:23], s69 offen offset:0 sc1
    buffer_load_dwordx4 v[152:155], v15, s[20:23], s70 offen offset:0 sc1
    buffer_load_dwordx4 v[156:159], v15, s[20:23], s71 offen offset:0 sc1
    buffer_load_dwordx4 v[160:163], v15, s[20:23], s72 offen offset:0 sc1
    buffer_load_dwordx4 v[164:167], v15, s[20:23], s73 offen offset:0 sc1
    s_waitcnt lgkmcnt(0)
    v_cmp_gt_u32 vcc, 11, v9
    s_cbranch_vccnz Lst_1162
Lrt_1163:
    s_waitcnt vmcnt(9)
    v_mfma_f32_32x32x16_bf16 v[16:31], v[48:51], v[128:131], 0
    ds_read_b64_tr_b16 v[48:49], v1 offset:0
    ds_read_b64_tr_b16 v[50:51], v1 offset:512
    v_mfma_f32_32x32x16_bf16 v[32:47], v[52:55], v[128:131], 0
    ds_read_b64_tr_b16 v[52:53], v2 offset:0
    ds_read_b64_tr_b16 v[54:55], v2 offset:512
    buffer_load_dwordx4 v[128:131], v15, s[20:23], s74 offen offset:0 sc1
    s_waitcnt vmcnt(9)
    v_mfma_f32_32x32x16_bf16 v[16:31], v[56:59], v[132:135], v[16:31]
    ds_read_b64_tr_b16 v[56:57], v1 offset:2048
    ds_read_b64_tr_b16 v[58:59], v1 offset:2560
    v_mfma_f32_32x32x16_bf16 v[32:47], v[60:63], v[132:135], v[32:47]
    ds_read_b64_tr_b16 v[60:61], v2 offset:2048
    ds_read_b64_tr_b16 v[62:63], v2 offset:2560
    buffer_load_dwordx4 v[132:135], v15, s[20:23], s75 offen offset:0 sc1
    s_waitcnt vmcnt(9)
    v_mfma_f32_32x32x16_bf16 v[16:31], v[64:67], v[136:139], v[16:31]
    ds_read_b64_tr_b16 v[64:65], v1 offset:4096
    ds_read_b64_tr_b16 v[66:67], v1 offset:4608
    v_mfma_f32_32x32x16_bf16 v[32:47], v[68:71], v[136:139], v[32:47]
    ds_read_b64_tr_b16 v[68:69], v2 offset:4096
    ds_read_b64_tr_b16 v[70:71], v2 offset:4608
    buffer_load_dwordx4 v[136:139], v15, s[20:23], s76 offen offset:0 sc1
    ds_read_b32 v12, v14
    ds_read_b32 v9, v7
    s_waitcnt vmcnt(9)
    v_mfma_f32_32x32x16_bf16 v[16:31], v[72:75], v[140:143], v[16:31]
    ds_read_b64_tr_b16 v[72:73], v1 offset:6144
    ds_read_b64_tr_b16 v[74:75], v1 offset:6656
    v_mfma_f32_32x32x16_bf16 v[32:47], v[76:79], v[140:143], v[32:47]
    ds_read_b64_tr_b16 v[76:77], v2 offset:6144
    ds_read_b64_tr_b16 v[78:79], v2 offset:6656
    buffer_load_dwordx4 v[140:143], v15, s[20:23], s77 offen offset:0 sc1
    s_waitcnt vmcnt(9)
    v_mfma_f32_32x32x16_bf16 v[16:31], v[80:83], v[144:147], v[16:31]
    ds_read_b64_tr_b16 v[80:81], v1 offset:8192
    ds_read_b64_tr_b16 v[82:83], v1 offset:8704
    v_mfma_f32_32x32x16_bf16 v[32:47], v[84:87], v[144:147], v[32:47]
    ds_read_b64_tr_b16 v[84:85], v2 offset:8192
    ds_read_b64_tr_b16 v[86:87], v2 offset:8704
    buffer_load_dwordx4 v[144:147], v15, s[20:23], s78 offen offset:0 sc1
    v_mov_b32 v10, 11
    ds_write_b32 v8, v10
    s_waitcnt lgkmcnt(9)
    v_cmp_gt_u32 vcc, 12, v9
    s_cbranch_vccnz Lst_1165
Lrt_1166:
    s_waitcnt vmcnt(9)
    v_mfma_f32_32x32x16_bf16 v[16:31], v[88:91], v[148:151], v[16:31]
    ds_read_b64_tr_b16 v[88:89], v1 offset:20480
    ds_read_b64_tr_b16 v[90:91], v1 offset:20992
    v_mfma_f32_32x32x16_bf16 v[32:47], v[92:95], v[148:151], v[32:47]
    ds_read_b64_tr_b16 v[92:93], v2 offset:20480
    ds_read_b64_tr_b16 v[94:95], v2 offset:20992
    v_cmp_gt_u32 vcc, 2, v12
    s_cbranch_vccnz Lst_1168
Lrt_1169:
    buffer_load_dwordx4 v[148:151], v15, s[20:23], s64 offen offset:1024 sc1
    s_waitcnt vmcnt(9)
    v_mfma_f32_32x32x16_bf16 v[16:31], v[96:99], v[152:155], v[16:31]
    ds_read_b64_tr_b16 v[96:97], v1 offset:22528
    ds_read_b64_tr_b16 v[98:99], v1 offset:23040
    v_mfma_f32_32x32x16_bf16 v[32:47], v[100:103], v[152:155], v[32:47]
    ds_read_b64_tr_b16 v[100:101], v2 offset:22528
    ds_read_b64_tr_b16 v[102:103], v2 offset:23040
    buffer_load_dwordx4 v[152:155], v15, s[20:23], s65 offen offset:1024 sc1
    s_waitcnt vmcnt(9)
    v_mfma_f32_32x32x16_bf16 v[16:31], v[104:107], v[156:159], v[16:31]
    ds_read_b64_tr_b16 v[104:105], v1 offset:24576
    ds_read_b64_tr_b16 v[106:107], v1 offset:25088
    v_mfma_f32_32x32x16_bf16 v[32:47], v[108:111], v[156:159], v[32:47]
    ds_read_b64_tr_b16 v[108:109], v2 offset:24576
    ds_read_b64_tr_b16 v[110:111], v2 offset:25088
    buffer_load_dwordx4 v[156:159], v15, s[20:23], s66 offen offset:1024 sc1
    ds_read_b32 v9, v7
    s_waitcnt vmcnt(9)
    v_mfma_f32_32x32x16_bf16 v[16:31], v[112:115], v[160:163], v[16:31]
    ds_read_b64_tr_b16 v[112:113], v1 offset:26624
    ds_read_b64_tr_b16 v[114:115], v1 offset:27136
    v_mfma_f32_32x32x16_bf16 v[32:47], v[116:119], v[160:163], v[32:47]
    ds_read_b64_tr_b16 v[116:117], v2 offset:26624
    ds_read_b64_tr_b16 v[118:119], v2 offset:27136
    buffer_load_dwordx4 v[160:163], v15, s[20:23], s67 offen offset:1024 sc1
    s_waitcnt vmcnt(9)
    v_mfma_f32_32x32x16_bf16 v[16:31], v[120:123], v[164:167], v[16:31]
    ds_read_b64_tr_b16 v[120:121], v1 offset:28672
    ds_read_b64_tr_b16 v[122:123], v1 offset:29184
    v_mfma_f32_32x32x16_bf16 v[32:47], v[124:127], v[164:167], v[32:47]
    ds_read_b64_tr_b16 v[124:125], v2 offset:28672
    ds_read_b64_tr_b16 v[126:127], v2 offset:29184
    buffer_load_dwordx4 v[164:167], v15, s[20:23], s68 offen offset:1024 sc1
    v_mov_b32 v10, 12
    ds_write_b32 v8, v10
    s_waitcnt lgkmcnt(9)
    v_cmp_gt_u32 vcc, 13, v9
    s_cbranch_vccnz Lst_1171
Lrt_1172:
    s_waitcnt vmcnt(9)
    v_mfma_f32_32x32x16_bf16 v[16:31], v[48:51], v[128:131], v[16:31]
    ds_read_b64_tr_b16 v[48:49], v3 offset:0
    ds_read_b64_tr_b16 v[50:51], v3 offset:512
    v_mfma_f32_32x32x16_bf16 v[32:47], v[52:55], v[128:131], v[32:47]
    ds_read_b64_tr_b16 v[52:53], v4 offset:0
    ds_read_b64_tr_b16 v[54:55], v4 offset:512
    buffer_load_dwordx4 v[128:131], v15, s[20:23], s69 offen offset:1024 sc1
    s_waitcnt vmcnt(9)
    v_mfma_f32_32x32x16_bf16 v[16:31], v[56:59], v[132:135], v[16:31]
    ds_read_b64_tr_b16 v[56:57], v3 offset:2048
    ds_read_b64_tr_b16 v[58:59], v3 offset:2560
    v_mfma_f32_32x32x16_bf16 v[32:47], v[60:63], v[132:135], v[32:47]
    ds_read_b64_tr_b16 v[60:61], v4 offset:2048
    ds_read_b64_tr_b16 v[62:63], v4 offset:2560
    buffer_load_dwordx4 v[132:135], v15, s[20:23], s70 offen offset:1024 sc1
    s_waitcnt vmcnt(9)
    v_mfma_f32_32x32x16_bf16 v[16:31], v[64:67], v[136:139], v[16:31]
    ds_read_b64_tr_b16 v[64:65], v3 offset:4096
    ds_read_b64_tr_b16 v[66:67], v3 offset:4608
    v_mfma_f32_32x32x16_bf16 v[32:47], v[68:71], v[136:139], v[32:47]
    ds_read_b64_tr_b16 v[68:69], v4 offset:4096
    ds_read_b64_tr_b16 v[70:71], v4 offset:4608
    buffer_load_dwordx4 v[136:139], v15, s[20:23], s71 offen offset:1024 sc1
    ds_read_b32 v9, v7
    s_waitcnt vmcnt(9)
    v_mfma_f32_32x32x16_bf16 v[16:31], v[72:75], v[140:143], v[16:31]
    ds_read_b64_tr_b16 v[72:73], v3 offset:6144
    ds_read_b64_tr_b16 v[74:75], v3 offset:6656
    v_mfma_f32_32x32x16_bf16 v[32:47], v[76:79], v[140:143], v[32:47]
    ds_read_b64_tr_b16 v[76:77], v4 offset:6144
    ds_read_b64_tr_b16 v[78:79], v4 offset:6656
    buffer_load_dwordx4 v[140:143], v15, s[20:23], s72 offen offset:1024 sc1
    s_waitcnt vmcnt(9)
    v_mfma_f32_32x32x16_bf16 v[16:31], v[80:83], v[144:147], v[16:31]
    ds_read_b64_tr_b16 v[80:81], v3 offset:8192
    ds_read_b64_tr_b16 v[82:83], v3 offset:8704
    v_mfma_f32_32x32x16_bf16 v[32:47], v[84:87], v[144:147], v[32:47]
    ds_read_b64_tr_b16 v[84:85], v4 offset:8192
    ds_read_b64_tr_b16 v[86:87], v4 offset:8704
    buffer_load_dwordx4 v[144:147], v15, s[20:23], s73 offen offset:1024 sc1
    v_mov_b32 v10, 13
    ds_write_b32 v8, v10
    s_waitcnt lgkmcnt(9)
    v_cmp_gt_u32 vcc, 14, v9
    s_cbranch_vccnz Lst_1174
Lrt_1175:
    s_waitcnt vmcnt(9)
    v_mfma_f32_32x32x16_bf16 v[16:31], v[88:91], v[148:151], v[16:31]
    ds_read_b64_tr_b16 v[88:89], v3 offset:20480
    ds_read_b64_tr_b16 v[90:91], v3 offset:20992
    v_mfma_f32_32x32x16_bf16 v[32:47], v[92:95], v[148:151], v[32:47]
    ds_read_b64_tr_b16 v[92:93], v4 offset:20480
    ds_read_b64_tr_b16 v[94:95], v4 offset:20992
    buffer_load_dwordx4 v[148:151], v15, s[20:23], s74 offen offset:1024 sc1
    s_waitcnt vmcnt(9)
    v_mfma_f32_32x32x16_bf16 v[16:31], v[96:99], v[152:155], v[16:31]
    ds_read_b64_tr_b16 v[96:97], v3 offset:22528
    ds_read_b64_tr_b16 v[98:99], v3 offset:23040
    v_mfma_f32_32x32x16_bf16 v[32:47], v[100:103], v[152:155], v[32:47]
    ds_read_b64_tr_b16 v[100:101], v4 offset:22528
    ds_read_b64_tr_b16 v[102:103], v4 offset:23040
    buffer_load_dwordx4 v[152:155], v15, s[20:23], s75 offen offset:1024 sc1
    s_waitcnt vmcnt(9)
    v_mfma_f32_32x32x16_bf16 v[16:31], v[104:107], v[156:159], v[16:31]
    ds_read_b64_tr_b16 v[104:105], v3 offset:24576
    ds_read_b64_tr_b16 v[106:107], v3 offset:25088
    v_mfma_f32_32x32x16_bf16 v[32:47], v[108:111], v[156:159], v[32:47]
    ds_read_b64_tr_b16 v[108:109], v4 offset:24576
    ds_read_b64_tr_b16 v[110:111], v4 offset:25088
    buffer_load_dwordx4 v[156:159], v15, s[20:23], s76 offen offset:1024 sc1
    ds_read_b32 v12, v14
    ds_read_b32 v9, v7
    s_waitcnt vmcnt(9)
    v_mfma_f32_32x32x16_bf16 v[16:31], v[112:115], v[160:163], v[16:31]
    ds_read_b64_tr_b16 v[112:113], v3 offset:26624
    ds_read_b64_tr_b16 v[114:115], v3 offset:27136
    v_mfma_f32_32x32x16_bf16 v[32:47], v[116:119], v[160:163], v[32:47]
    ds_read_b64_tr_b16 v[116:117], v4 offset:26624
    ds_read_b64_tr_b16 v[118:119], v4 offset:27136
    buffer_load_dwordx4 v[160:163], v15, s[20:23], s77 offen offset:1024 sc1
    s_waitcnt vmcnt(9)
    v_mfma_f32_32x32x16_bf16 v[16:31], v[120:123], v[164:167], v[16:31]
    ds_read_b64_tr_b16 v[120:121], v3 offset:28672
    ds_read_b64_tr_b16 v[122:123], v3 offset:29184
    v_mfma_f32_32x32x16_bf16 v[32:47], v[124:127], v[164:167], v[32:47]
    ds_read_b64_tr_b16 v[124:125], v4 offset:28672
    ds_read_b64_tr_b16 v[126:127], v4 offset:29184
    buffer_load_dwordx4 v[164:167], v15, s[20:23], s78 offen offset:1024 sc1
    v_mov_b32 v10, 14
    ds_write_b32 v8, v10
    s_waitcnt lgkmcnt(9)
    v_cmp_gt_u32 vcc, 15, v9
    s_cbranch_vccnz Lst_1177
Lrt_1178:
    s_waitcnt vmcnt(9)
    v_mfma_f32_32x32x16_bf16 v[16:31], v[48:51], v[128:131], v[16:31]
    ds_read_b64_tr_b16 v[48:49], v5 offset:0
    ds_read_b64_tr_b16 v[50:51], v5 offset:512
    v_mfma_f32_32x32x16_bf16 v[32:47], v[52:55], v[128:131], v[32:47]
    ds_read_b64_tr_b16 v[52:53], v6 offset:0
    ds_read_b64_tr_b16 v[54:55], v6 offset:512
    v_cmp_gt_u32 vcc, 3, v12
    s_cbranch_vccnz Lst_1180
Lrt_1181:
    buffer_load_dwordx4 v[128:131], v15, s[20:23], s64 offen offset:2048 sc1
    s_waitcnt vmcnt(9)
    v_mfma_f32_32x32x16_bf16 v[16:31], v[56:59], v[132:135], v[16:31]
    ds_read_b64_tr_b16 v[56:57], v5 offset:2048
    ds_read_b64_tr_b16 v[58:59], v5 offset:2560
    v_mfma_f32_32x32x16_bf16 v[32:47], v[60:63], v[132:135], v[32:47]
    ds_read_b64_tr_b16 v[60:61], v6 offset:2048
    ds_read_b64_tr_b16 v[62:63], v6 offset:2560
    buffer_load_dwordx4 v[132:135], v15, s[20:23], s65 offen offset:2048 sc1
    s_waitcnt vmcnt(9)
    v_mfma_f32_32x32x16_bf16 v[16:31], v[64:67], v[136:139], v[16:31]
    ds_read_b64_tr_b16 v[64:65], v5 offset:4096
    ds_read_b64_tr_b16 v[66:67], v5 offset:4608
    v_mfma_f32_32x32x16_bf16 v[32:47], v[68:71], v[136:139], v[32:47]
    ds_read_b64_tr_b16 v[68:69], v6 offset:4096
    ds_read_b64_tr_b16 v[70:71], v6 offset:4608
    buffer_load_dwordx4 v[136:139], v15, s[20:23], s66 offen offset:2048 sc1
    ds_read_b32 v9, v7
    s_waitcnt vmcnt(9)
    v_mfma_f32_32x32x16_bf16 v[16:31], v[72:75], v[140:143], v[16:31]
    ds_read_b64_tr_b16 v[72:73], v5 offset:6144
    ds_read_b64_tr_b16 v[74:75], v5 offset:6656
    v_mfma_f32_32x32x16_bf16 v[32:47], v[76:79], v[140:143], v[32:47]
    ds_read_b64_tr_b16 v[76:77], v6 offset:6144
    ds_read_b64_tr_b16 v[78:79], v6 offset:6656
    buffer_load_dwordx4 v[140:143], v15, s[20:23], s67 offen offset:2048 sc1
    s_waitcnt vmcnt(9)
    v_mfma_f32_32x32x16_bf16 v[16:31], v[80:83], v[144:147], v[16:31]
    ds_read_b64_tr_b16 v[80:81], v5 offset:8192
    ds_read_b64_tr_b16 v[82:83], v5 offset:8704
    v_mfma_f32_32x32x16_bf16 v[32:47], v[84:87], v[144:147], v[32:47]
    ds_read_b64_tr_b16 v[84:85], v6 offset:8192
    ds_read_b64_tr_b16 v[86:87], v6 offset:8704
    buffer_load_dwordx4 v[144:147], v15, s[20:23], s68 offen offset:2048 sc1
    v_mov_b32 v10, 15
    ds_write_b32 v8, v10
    s_waitcnt lgkmcnt(9)
    v_cmp_gt_u32 vcc, 16, v9
    s_cbranch_vccnz Lst_1183
Lrt_1184:
    s_waitcnt vmcnt(9)
    v_mfma_f32_32x32x16_bf16 v[16:31], v[88:91], v[148:151], v[16:31]
    ds_read_b64_tr_b16 v[88:89], v5 offset:20480
    ds_read_b64_tr_b16 v[90:91], v5 offset:20992
    v_mfma_f32_32x32x16_bf16 v[32:47], v[92:95], v[148:151], v[32:47]
    ds_read_b64_tr_b16 v[92:93], v6 offset:20480
    ds_read_b64_tr_b16 v[94:95], v6 offset:20992
    buffer_load_dwordx4 v[148:151], v15, s[20:23], s69 offen offset:2048 sc1
    s_waitcnt vmcnt(9)
    v_mfma_f32_32x32x16_bf16 v[16:31], v[96:99], v[152:155], v[16:31]
    ds_read_b64_tr_b16 v[96:97], v5 offset:22528
    ds_read_b64_tr_b16 v[98:99], v5 offset:23040
    v_mfma_f32_32x32x16_bf16 v[32:47], v[100:103], v[152:155], v[32:47]
    ds_read_b64_tr_b16 v[100:101], v6 offset:22528
    ds_read_b64_tr_b16 v[102:103], v6 offset:23040
    buffer_load_dwordx4 v[152:155], v15, s[20:23], s70 offen offset:2048 sc1
    s_waitcnt vmcnt(9)
    v_mfma_f32_32x32x16_bf16 v[16:31], v[104:107], v[156:159], v[16:31]
    ds_read_b64_tr_b16 v[104:105], v5 offset:24576
    ds_read_b64_tr_b16 v[106:107], v5 offset:25088
    v_mfma_f32_32x32x16_bf16 v[32:47], v[108:111], v[156:159], v[32:47]
    ds_read_b64_tr_b16 v[108:109], v6 offset:24576
    ds_read_b64_tr_b16 v[110:111], v6 offset:25088
    buffer_load_dwordx4 v[156:159], v15, s[20:23], s71 offen offset:2048 sc1
    ds_read_b32 v9, v7
    s_waitcnt vmcnt(9)
    v_mfma_f32_32x32x16_bf16 v[16:31], v[112:115], v[160:163], v[16:31]
    ds_read_b64_tr_b16 v[112:113], v5 offset:26624
    ds_read_b64_tr_b16 v[114:115], v5 offset:27136
    v_mfma_f32_32x32x16_bf16 v[32:47], v[116:119], v[160:163], v[32:47]
    ds_read_b64_tr_b16 v[116:117], v6 offset:26624
    ds_read_b64_tr_b16 v[118:119], v6 offset:27136
    buffer_load_dwordx4 v[160:163], v15, s[20:23], s72 offen offset:2048 sc1
    s_waitcnt vmcnt(9)
    v_mfma_f32_32x32x16_bf16 v[16:31], v[120:123], v[164:167], v[16:31]
    ds_read_b64_tr_b16 v[120:121], v5 offset:28672
    ds_read_b64_tr_b16 v[122:123], v5 offset:29184
    v_mfma_f32_32x32x16_bf16 v[32:47], v[124:127], v[164:167], v[32:47]
    ds_read_b64_tr_b16 v[124:125], v6 offset:28672
    ds_read_b64_tr_b16 v[126:127], v6 offset:29184
    buffer_load_dwordx4 v[164:167], v15, s[20:23], s73 offen offset:2048 sc1
    v_mov_b32 v10, 16
    ds_write_b32 v8, v10
    s_waitcnt lgkmcnt(9)
    v_cmp_gt_u32 vcc, 17, v9
    s_cbranch_vccnz Lst_1186
Lrt_1187:
    s_waitcnt vmcnt(9)
    v_mfma_f32_32x32x16_bf16 v[16:31], v[48:51], v[128:131], v[16:31]
    ds_read_b64_tr_b16 v[48:49], v1 offset:0
    ds_read_b64_tr_b16 v[50:51], v1 offset:512
    v_mfma_f32_32x32x16_bf16 v[32:47], v[52:55], v[128:131], v[32:47]
    ds_read_b64_tr_b16 v[52:53], v2 offset:0
    ds_read_b64_tr_b16 v[54:55], v2 offset:512
    buffer_load_dwordx4 v[128:131], v15, s[20:23], s74 offen offset:2048 sc1
    s_waitcnt vmcnt(9)
    v_mfma_f32_32x32x16_bf16 v[16:31], v[56:59], v[132:135], v[16:31]
    ds_read_b64_tr_b16 v[56:57], v1 offset:2048
    ds_read_b64_tr_b16 v[58:59], v1 offset:2560
    v_mfma_f32_32x32x16_bf16 v[32:47], v[60:63], v[132:135], v[32:47]
    ds_read_b64_tr_b16 v[60:61], v2 offset:2048
    ds_read_b64_tr_b16 v[62:63], v2 offset:2560
    buffer_load_dwordx4 v[132:135], v15, s[20:23], s75 offen offset:2048 sc1
    s_waitcnt vmcnt(9)
    v_mfma_f32_32x32x16_bf16 v[16:31], v[64:67], v[136:139], v[16:31]
    ds_read_b64_tr_b16 v[64:65], v1 offset:4096
    ds_read_b64_tr_b16 v[66:67], v1 offset:4608
    v_mfma_f32_32x32x16_bf16 v[32:47], v[68:71], v[136:139], v[32:47]
    ds_read_b64_tr_b16 v[68:69], v2 offset:4096
    ds_read_b64_tr_b16 v[70:71], v2 offset:4608
    buffer_load_dwordx4 v[136:139], v15, s[20:23], s76 offen offset:2048 sc1
    s_waitcnt vmcnt(9)
    v_mfma_f32_32x32x16_bf16 v[16:31], v[72:75], v[140:143], v[16:31]
    ds_read_b64_tr_b16 v[72:73], v1 offset:6144
    ds_read_b64_tr_b16 v[74:75], v1 offset:6656
    v_mfma_f32_32x32x16_bf16 v[32:47], v[76:79], v[140:143], v[32:47]
    ds_read_b64_tr_b16 v[76:77], v2 offset:6144
    ds_read_b64_tr_b16 v[78:79], v2 offset:6656
    buffer_load_dwordx4 v[140:143], v15, s[20:23], s77 offen offset:2048 sc1
    s_waitcnt vmcnt(9)
    v_mfma_f32_32x32x16_bf16 v[16:31], v[80:83], v[144:147], v[16:31]
    v_and_b32 v13, 3, v0
    v_lshlrev_b32 v13, 2, v13
    v_add_u32 v13, 156288, v13
    v_add_u32 v7, 64, v13
    v_mfma_f32_32x32x16_bf16 v[32:47], v[84:87], v[144:147], v[32:47]
    v_lshlrev_b32 v6, 4, v0
    s_lshl_b32 s48, s41, 13
    s_add_u32 s48, s48, 122976
    v_add_u32 v6, s48, v6
    s_waitcnt vmcnt(8)
    v_mfma_f32_32x32x16_bf16 v[16:31], v[88:91], v[148:151], v[16:31]
    v_and_b32 v12, 31, v0
    v_lshrrev_b32 v10, 5, v0
    v_lshlrev_b32 v10, 2, v10
    v_sub_u32 v12, v12, v10
    v_mfma_f32_32x32x16_bf16 v[32:47], v[92:95], v[148:151], v[32:47]
    v_and_b32 v10, 1, v12
    v_lshlrev_b32 v10, 4, v10
    v_mov_b32 v14, 0x3f80
    v_lshlrev_b32 v14, v10, v14
    buffer_load_dwordx4 v[88:91], v11, s[12:15], s61 offen
    buffer_load_dwordx4 v[92:95], v11, s[12:15], s60 offen
    s_waitcnt vmcnt(9)
    v_mfma_f32_32x32x16_bf16 v[16:31], v[96:99], v[152:155], v[16:31]
    v_and_b32 v12, -2, v12
    ds_read_b32 v15, v13
    ds_read_b32 v9, v7
    v_cmp_eq_u32 s[4:5], 0, v12
    v_mfma_f32_32x32x16_bf16 v[32:47], v[100:103], v[152:155], v[32:47]
    v_cmp_eq_u32 s[6:7], 2, v12
    s_waitcnt vmcnt(8)
    v_mfma_f32_32x32x16_bf16 v[16:31], v[104:107], v[156:159], v[16:31]
    v_cndmask_b32 v80, 0, v14, s[4:5]
    v_cndmask_b32 v81, 0, v14, s[6:7]
    v_cmp_eq_u32 s[4:5], 8, v12
    v_cmp_eq_u32 s[6:7], 10, v12
    v_mfma_f32_32x32x16_bf16 v[32:47], v[108:111], v[156:159], v[32:47]
    s_waitcnt vmcnt(7) lgkmcnt(15)
    v_mfma_f32_32x32x16_bf16 v[16:31], v[112:115], v[160:163], v[16:31]
    v_cndmask_b32 v82, 0, v14, s[4:5]
    v_cndmask_b32 v83, 0, v14, s[6:7]
    v_cmp_eq_u32 s[4:5], 16, v12
    v_cmp_eq_u32 s[6:7], 18, v12
    v_mfma_f32_32x32x16_bf16 v[32:47], v[116:119], v[160:163], v[32:47]
    s_waitcnt vmcnt(6)
    v_mfma_f32_32x32x16_bf16 v[16:31], v[120:123], v[164:167], v[16:31]
    v_cndmask_b32 v84, 0, v14, s[4:5]
    v_cndmask_b32 v85, 0, v14, s[6:7]
    v_cmp_eq_u32 s[4:5], 24, v12
    v_cmp_eq_u32 s[6:7], 26, v12
    v_mfma_f32_32x32x16_bf16 v[32:47], v[124:127], v[164:167], v[32:47]
    s_waitcnt lgkmcnt(1)
    v_cmp_gt_u32 vcc, 14, v15
    s_cbranch_vccnz Lst_1189
Lrt_1190:
    s_waitcnt lgkmcnt(0)
    v_cmp_gt_u32 vcc, 1, v9
    s_cbranch_vccnz Lst_1192
Lrt_1193:
    ds_read_b128 v[144:147], v6 offset:0
    ds_read_b128 v[148:151], v6 offset:1024
    ds_read_b128 v[152:155], v6 offset:2048
    ds_read_b128 v[156:159], v6 offset:3072
    ds_read_b128 v[160:163], v6 offset:4096
    ds_read_b128 v[164:167], v6 offset:5120
    ds_read_b128 v[112:115], v6 offset:6144
    ds_read_b128 v[116:119], v6 offset:7168
    s_waitcnt vmcnt(5)
    v_mfma_f32_32x32x16_bf16 v[16:31], v[48:51], v[128:131], v[16:31]
    v_cndmask_b32 v86, 0, v14, s[4:5]
    v_cndmask_b32 v87, 0, v14, s[6:7]
    v_and_b32 v12, 31, v0
    v_mul_u32_u24 v12, 272, v12
    v_mfma_f32_32x32x16_bf16 v[32:47], v[52:55], v[128:131], v[32:47]
    v_lshrrev_b32 v10, 5, v0
    v_lshl_add_u32 v12, v10, 6, v12
    s_mul_i32 s48, s41, 8704
    s_add_u32 s48, s48, 40992
    s_waitcnt vmcnt(4)
    v_mfma_f32_32x32x16_bf16 v[16:31], v[56:59], v[132:135], v[16:31]
    s_lshl_b32 s47, s53, 7
    s_add_u32 s49, s48, s47
    v_add_u32 v1, s49, v12
    s_xor_b32 s47, s47, 128
    v_mfma_f32_32x32x16_bf16 v[32:47], v[60:63], v[132:135], v[32:47]
    s_add_u32 s49, s48, s47
    v_add_u32 v2, s49, v12
    s_lshl_b32 s47, s41, 2
    s_add_u32 s47, s47, 156368
    s_waitcnt vmcnt(3)
    v_mfma_f32_32x32x16_bf16 v[16:31], v[64:67], v[136:139], v[16:31]
    v_mov_b32 v8, s47
    v_mov_b32 v3, 1
    v_xor_b32 v4, 4, v8
    v_lshrrev_b32 v10, 16, v11
    v_mfma_f32_32x32x16_bf16 v[32:47], v[68:71], v[136:139], v[32:47]
    v_mul_u32_u24 v12, 272, v10
    v_and_b32 v5, 7, v0
    v_lshl_add_u32 v12, v5, 5, v12
    s_mul_i32 s47, s52, 17408
    s_waitcnt vmcnt(2)
    v_mfma_f32_32x32x16_bf16 v[16:31], v[72:75], v[140:143], v[16:31]
    s_add_u32 s47, s47, 40992
    v_add_u32 v12, s47, v12
    v_mfma_f32_32x32x16_bf16 v[32:47], v[76:79], v[140:143], v[32:47]
    s_waitcnt lgkmcnt(7)
    v_mfma_f32_32x32x16_bf16 v[16:31], v[80:83], v[144:147], v[16:31]
    s_waitcnt vmcnt(1)
    v_lshlrev_b32 v96, 16, v88
    v_and_b32 v97, 0xffff0000, v88
    v_lshlrev_b32 v98, 16, v89
    v_and_b32 v99, 0xffff0000, v89
    s_waitcnt lgkmcnt(6)
    v_mfma_f32_32x32x16_bf16 v[16:31], v[84:87], v[148:151], v[16:31]
    v_lshlrev_b32 v100, 16, v90
    v_and_b32 v101, 0xffff0000, v90
    v_lshlrev_b32 v102, 16, v91
    v_and_b32 v103, 0xffff0000, v91
    s_waitcnt lgkmcnt(5)
    v_mfma_f32_32x32x16_bf16 v[16:31], v[80:83], v[152:155], v[16:31]
    s_waitcnt vmcnt(0)
    v_lshlrev_b32 v104, 16, v92
    v_and_b32 v105, 0xffff0000, v92
    v_lshlrev_b32 v106, 16, v93
    v_and_b32 v107, 0xffff0000, v93
    s_waitcnt lgkmcnt(4)
    v_mfma_f32_32x32x16_bf16 v[16:31], v[84:87], v[156:159], v[16:31]
    v_lshlrev_b32 v108, 16, v94
    v_and_b32 v109, 0xffff0000, v94
    v_lshlrev_b32 v110, 16, v95
    v_and_b32 v111, 0xffff0000, v95
    s_waitcnt lgkmcnt(3)
    v_mfma_f32_32x32x16_bf16 v[16:31], v[80:83], v[160:163], v[16:31]
    ds_write_b128 v2, v[32:35] offset:0
    s_waitcnt lgkmcnt(3)
    v_mfma_f32_32x32x16_bf16 v[16:31], v[84:87], v[164:167], v[16:31]
    ds_write_b128 v2, v[36:39] offset:16
    s_waitcnt lgkmcnt(3)
    v_mfma_f32_32x32x16_bf16 v[16:31], v[80:83], v[112:115], v[16:31]
    ds_write_b128 v2, v[40:43] offset:32
    s_waitcnt lgkmcnt(3)
    v_mfma_f32_32x32x16_bf16 v[16:31], v[84:87], v[116:119], v[16:31]
    ds_write_b128 v2, v[44:47] offset:48
    s_nop 10
    ds_write_b128 v1, v[16:19] offset:0
    ds_write_b128 v1, v[20:23] offset:16
    ds_write_b128 v1, v[24:27] offset:32
    ds_write_b128 v1, v[28:31] offset:48
    ds_write_b32 v8, v3
    ds_read_b32 v9, v4
    s_waitcnt lgkmcnt(0)
    v_cmp_gt_u32 vcc, 1, v9
    s_cbranch_vccnz Lst_1195
Lrt_1196:
    ds_read_b128 v[16:19], v12 offset:0
    ds_read_b128 v[20:23], v12 offset:16
    ds_read_b128 v[32:35], v12 offset:8704
    ds_read_b128 v[36:39], v12 offset:8720
    ds_read_b128 v[24:27], v12 offset:2176
    ds_read_b128 v[28:31], v12 offset:2192
    ds_read_b128 v[40:43], v12 offset:10880
    ds_read_b128 v[44:47], v12 offset:10896
    s_waitcnt lgkmcnt(7)
    v_pk_add_f32 v[16:17], v[16:17], v[96:97]
    v_pk_add_f32 v[18:19], v[18:19], v[98:99]
    s_waitcnt lgkmcnt(6)
    v_pk_add_f32 v[20:21], v[20:21], v[100:101]
    v_pk_add_f32 v[22:23], v[22:23], v[102:103]
    s_waitcnt lgkmcnt(5)
    v_pk_add_f32 v[16:17], v[16:17], v[32:33]
    v_pk_add_f32 v[18:19], v[18:19], v[34:35]
    s_waitcnt lgkmcnt(4)
    v_pk_add_f32 v[20:21], v[20:21], v[36:37]
    v_pk_add_f32 v[22:23], v[22:23], v[38:39]
    v_cvt_pk_bf16_f32 v128, v16, v17
    v_cvt_pk_bf16_f32 v129, v18, v19
    v_cvt_pk_bf16_f32 v130, v20, v21
    v_cvt_pk_bf16_f32 v131, v22, v23
    buffer_store_dwordx4 v[128:131], v11, s[8:11], s61 offen sc1
    s_waitcnt lgkmcnt(3)
    v_pk_add_f32 v[24:25], v[24:25], v[104:105]
    v_pk_add_f32 v[26:27], v[26:27], v[106:107]
    s_waitcnt lgkmcnt(2)
    v_pk_add_f32 v[28:29], v[28:29], v[108:109]
    v_pk_add_f32 v[30:31], v[30:31], v[110:111]
    s_waitcnt lgkmcnt(1)
    v_pk_add_f32 v[24:25], v[24:25], v[40:41]
    v_pk_add_f32 v[26:27], v[26:27], v[42:43]
    s_waitcnt lgkmcnt(0)
    v_pk_add_f32 v[28:29], v[28:29], v[44:45]
    v_pk_add_f32 v[30:31], v[30:31], v[46:47]
    v_cvt_pk_bf16_f32 v132, v24, v25
    v_cvt_pk_bf16_f32 v133, v26, v27
    v_cvt_pk_bf16_f32 v134, v28, v29
    v_cvt_pk_bf16_f32 v135, v30, v31
    buffer_store_dwordx4 v[132:135], v11, s[8:11], s60 offen sc1
    s_endpgm
Lst_1120:
    s_mov_b32 s46, 200000
Llp_1122:
    s_sleep 1
    ds_read_b32 v100, v103
    s_waitcnt lgkmcnt(0)
    v_cmp_gt_u32 vcc, 1, v100
    s_cbranch_vccz Lrt_1121
    s_sub_u32 s46, s46, 1
    s_cbranch_scc0 Llp_1122
    s_branch Lrt_1121
Lst_1123:
    s_mov_b32 s46, 200000
Llp_1125:
    s_sleep 1
    ds_read_b32 v9, v103
    s_waitcnt lgkmcnt(0)
    v_cmp_gt_u32 vcc, 1, v9
    s_cbranch_vccz Lrt_1124
    s_sub_u32 s46, s46, 1
    s_cbranch_scc0 Llp_1125
    s_branch Lrt_1124
Lst_1126:
    s_mov_b32 s46, 200000
Llp_1128:
    s_sleep 2
    ds_read_b32 v9, v7
    s_waitcnt lgkmcnt(0)
    v_cmp_gt_u32 vcc, 1, v9
    s_cbranch_vccz Lrt_1127
    s_sub_u32 s46, s46, 1
    s_cbranch_scc0 Llp_1128
    s_branch Lrt_1127
Lst_1129:
    s_mov_b32 s46, 200000
Llp_1131:
    s_sleep 1
    ds_read_b32 v9, v7
    s_waitcnt lgkmcnt(0)
    v_cmp_gt_u32 vcc, 2, v9
    s_cbranch_vccz Lrt_1130
    s_sub_u32 s46, s46, 1
    s_cbranch_scc0 Llp_1131
    s_branch Lrt_1130
Lst_1132:
    s_mov_b32 s46, 200000
Llp_1134:
    s_sleep 1
    ds_read_b32 v9, v7
    s_waitcnt lgkmcnt(0)
    v_cmp_gt_u32 vcc, 3, v9
    s_cbranch_vccz Lrt_1133
    s_sub_u32 s46, s46, 1
    s_cbranch_scc0 Llp_1134
    s_branch Lrt_1133
Lst_1135:
    s_mov_b32 s46, 200000
Llp_1137:
    s_sleep 1
    ds_read_b32 v9, v7
    s_waitcnt lgkmcnt(0)
    v_cmp_gt_u32 vcc, 4, v9
    s_cbranch_vccz Lrt_1136
    s_sub_u32 s46, s46, 1
    s_cbranch_scc0 Llp_1137
    s_branch Lrt_1136
Lst_1138:
    s_mov_b32 s46, 200000
Llp_1140:
    s_sleep 1
    ds_read_b32 v9, v7
    s_waitcnt lgkmcnt(0)
    v_cmp_gt_u32 vcc, 5, v9
    s_cbranch_vccz Lrt_1139
    s_sub_u32 s46, s46, 1
    s_cbranch_scc0 Llp_1140
    s_branch Lrt_1139
Lst_1141:
    s_mov_b32 s46, 200000
Llp_1143:
    s_sleep 1
    ds_read_b32 v9, v7
    s_waitcnt lgkmcnt(0)
    v_cmp_gt_u32 vcc, 6, v9
    s_cbranch_vccz Lrt_1142
    s_sub_u32 s46, s46, 1
    s_cbranch_scc0 Llp_1143
    s_branch Lrt_1142
Lst_1144:
    s_mov_b32 s46, 200000
Llp_1146:
    s_sleep 1
    ds_read_b32 v9, v7
    s_waitcnt lgkmcnt(0)
    v_cmp_gt_u32 vcc, 7, v9
    s_cbranch_vccz Lrt_1145
    s_sub_u32 s46, s46, 1
    s_cbranch_scc0 Llp_1146
    s_branch Lrt_1145
Lst_1147:
    s_mov_b32 s46, 200000
Llp_1149:
    s_sleep 1
    ds_read_b32 v9, v7
    s_waitcnt lgkmcnt(0)
    v_cmp_gt_u32 vcc, 8, v9
    s_cbranch_vccz Lrt_1148
    s_sub_u32 s46, s46, 1
    s_cbranch_scc0 Llp_1149
    s_branch Lrt_1148
Lst_1150:
    s_mov_b32 s46, 200000
Llp_1152:
    ds_read_b32 v9, v15
    s_waitcnt lgkmcnt(0)
    v_cmp_gt_u32 vcc, 1, v9
    s_cbranch_vccz Lrt_1151
    s_sub_u32 s46, s46, 1
    s_cbranch_scc0 Llp_1152
    s_branch Lrt_1151
Lst_1153:
    s_mov_b32 s46, 200000
Llp_1155:
    s_sleep 1
    ds_read_b32 v9, v7
    s_waitcnt lgkmcnt(0)
    v_cmp_gt_u32 vcc, 9, v9
    s_cbranch_vccz Lrt_1154
    s_sub_u32 s46, s46, 1
    s_cbranch_scc0 Llp_1155
    s_branch Lrt_1154
Lst_1156:
    s_mov_b32 s46, 200000
Llp_1158:
    s_sleep 1
    ds_read_b32 v9, v7
    s_waitcnt lgkmcnt(0)
    v_cmp_gt_u32 vcc, 10, v9
    s_cbranch_vccz Lrt_1157
    s_sub_u32 s46, s46, 1
    s_cbranch_scc0 Llp_1158
    s_branch Lrt_1157
Lst_1159:
    s_mov_b32 s46, 200000
Llp_1161:
    s_sleep 1
    ds_read_b32 v9, v14
    s_waitcnt lgkmcnt(0)
    v_cmp_gt_u32 vcc, 1, v9
    s_cbranch_vccz Lrt_1160
    s_sub_u32 s46, s46, 1
    s_cbranch_scc0 Llp_1161
    s_branch Lrt_1160
Lst_1162:
    s_mov_b32 s46, 200000
Llp_1164:
    s_sleep 1
    ds_read_b32 v9, v7
    s_waitcnt lgkmcnt(0)
    v_cmp_gt_u32 vcc, 11, v9
    s_cbranch_vccz Lrt_1163
    s_sub_u32 s46, s46, 1
    s_cbranch_scc0 Llp_1164
    s_branch Lrt_1163
Lst_1165:
    s_mov_b32 s46, 200000
Llp_1167:
    s_sleep 1
    ds_read_b32 v9, v7
    s_waitcnt lgkmcnt(0)
    v_cmp_gt_u32 vcc, 12, v9
    s_cbranch_vccz Lrt_1166
    s_sub_u32 s46, s46, 1
    s_cbranch_scc0 Llp_1167
    s_branch Lrt_1166
Lst_1168:
    s_mov_b32 s46, 200000
Llp_1170:
    s_sleep 1
    ds_read_b32 v12, v14
    s_waitcnt lgkmcnt(0)
    v_cmp_gt_u32 vcc, 2, v12
    s_cbranch_vccz Lrt_1169
    s_sub_u32 s46, s46, 1
    s_cbranch_scc0 Llp_1170
    s_branch Lrt_1169
Lst_1171:
    s_mov_b32 s46, 200000
Llp_1173:
    s_sleep 1
    ds_read_b32 v9, v7
    s_waitcnt lgkmcnt(0)
    v_cmp_gt_u32 vcc, 13, v9
    s_cbranch_vccz Lrt_1172
    s_sub_u32 s46, s46, 1
    s_cbranch_scc0 Llp_1173
    s_branch Lrt_1172
Lst_1174:
    s_mov_b32 s46, 200000
Llp_1176:
    s_sleep 1
    ds_read_b32 v9, v7
    s_waitcnt lgkmcnt(0)
    v_cmp_gt_u32 vcc, 14, v9
    s_cbranch_vccz Lrt_1175
    s_sub_u32 s46, s46, 1
    s_cbranch_scc0 Llp_1176
    s_branch Lrt_1175
Lst_1177:
    s_mov_b32 s46, 200000
Llp_1179:
    s_sleep 1
    ds_read_b32 v9, v7
    s_waitcnt lgkmcnt(0)
    v_cmp_gt_u32 vcc, 15, v9
    s_cbranch_vccz Lrt_1178
    s_sub_u32 s46, s46, 1
    s_cbranch_scc0 Llp_1179
    s_branch Lrt_1178
Lst_1180:
    s_mov_b32 s46, 200000
Llp_1182:
    s_sleep 1
    ds_read_b32 v12, v14
    s_waitcnt lgkmcnt(0)
    v_cmp_gt_u32 vcc, 3, v12
    s_cbranch_vccz Lrt_1181
    s_sub_u32 s46, s46, 1
    s_cbranch_scc0 Llp_1182
    s_branch Lrt_1181
Lst_1183:
    s_mov_b32 s46, 200000
Llp_1185:
    s_sleep 1
    ds_read_b32 v9, v7
    s_waitcnt lgkmcnt(0)
    v_cmp_gt_u32 vcc, 16, v9
    s_cbranch_vccz Lrt_1184
    s_sub_u32 s46, s46, 1
    s_cbranch_scc0 Llp_1185
    s_branch Lrt_1184
Lst_1186:
    s_mov_b32 s46, 200000
Llp_1188:
    s_sleep 1
    ds_read_b32 v9, v7
    s_waitcnt lgkmcnt(0)
    v_cmp_gt_u32 vcc, 17, v9
    s_cbranch_vccz Lrt_1187
    s_sub_u32 s46, s46, 1
    s_cbranch_scc0 Llp_1188
    s_branch Lrt_1187
Lst_1189:
    s_mov_b32 s46, 200000
Llp_1191:
    s_sleep 1
    ds_read_b32 v15, v13
    s_waitcnt lgkmcnt(0)
    v_cmp_gt_u32 vcc, 14, v15
    s_cbranch_vccz Lrt_1190
    s_sub_u32 s46, s46, 1
    s_cbranch_scc0 Llp_1191
    s_branch Lrt_1190
Lst_1192:
    s_mov_b32 s46, 200000
Llp_1194:
    ds_read_b32 v9, v7
    s_waitcnt lgkmcnt(0)
    v_cmp_gt_u32 vcc, 1, v9
    s_cbranch_vccz Lrt_1193
    s_sub_u32 s46, s46, 1
    s_cbranch_scc0 Llp_1194
    s_branch Lrt_1193
Lst_1195:
    s_mov_b32 s46, 200000
Llp_1197:
    ds_read_b32 v9, v4
    s_waitcnt lgkmcnt(0)
    v_cmp_gt_u32 vcc, 1, v9
    s_cbranch_vccz Lrt_1196
    s_sub_u32 s46, s46, 1
    s_cbranch_scc0 Llp_1197
    s_branch Lrt_1196
Lcskip_1118:
    s_cmp_eq_u32 s2, 0xff
    s_cbranch_scc1 Llast_1198
    s_lshr_b32 s50, s42, 2
    s_lshl_b32 s50, s50, 3
    s_and_b32 s47, s43, 7
    s_add_u32 s50, s50, s47
    s_and_b32 s51, s42, 3
    s_lshl_b32 s51, s51, 2
    s_lshr_b32 s47, s43, 3
    s_add_u32 s51, s51, s47
    s_mov_b32 s12, s72
    s_mov_b32 s13, s73
    s_mov_b32 s14, 1409024
    s_mov_b32 s15, 0x00020000
    s_mov_b32 s16, s74
    s_mov_b32 s17, s75
    s_mov_b32 s18, 1409024
    s_mov_b32 s19, 0x00020000
    s_cmp_eq_u32 s50, 14
    s_cselect_b32 s52, 4, 64
    s_cmp_eq_u32 s50, 15
    s_cselect_b32 s52, 0, s52
    v_mov_b32 v14, 0x7f000000
    s_mov_b32 s48, 0x15555556
    s_movk_i32 s49, 2752
    v_add_u32 v10, 0, v0
    v_mul_hi_u32 v11, v10, s48
    v_mul_u32_u24 v12, 12, v11
    v_sub_u32 v12, v10, v12
    v_mul_lo_u32 v11, v11, s49
    v_lshl_add_u32 v2, v12, 4, v11
    v_cmp_le_u32 vcc, s52, v12
    s_nop 1
    v_cndmask_b32 v2, v2, v14, vcc
    v_add_u32 v10, 64, v0
    v_mul_hi_u32 v11, v10, s48
    v_mul_u32_u24 v12, 12, v11
    v_sub_u32 v12, v10, v12
    v_mul_lo_u32 v11, v11, s49
    v_lshl_add_u32 v3, v12, 4, v11
    v_cmp_le_u32 vcc, s52, v12
    s_nop 1
    v_cndmask_b32 v3, v3, v14, vcc
    v_add_u32 v10, 128, v0
    v_mul_hi_u32 v11, v10, s48
    v_mul_u32_u24 v12, 12, v11
    v_sub_u32 v12, v10, v12
    v_mul_lo_u32 v11, v11, s49
    v_lshl_add_u32 v4, v12, 4, v11
    v_cmp_le_u32 vcc, s52, v12
    s_nop 1
    v_cndmask_b32 v4, v4, v14, vcc
    s_mul_i32 s60, s50, 192
    s_mul_i32 s47, s41, 352256
    s_add_u32 s60, s60, s47
    s_mul_i32 s63, s41, 30720
    s_add_u32 s61, s60, 0
    s_add_u32 m0, s63, 0
    s_nop 0
    buffer_load_dwordx4 v2, s[12:15], s61 offen lds
    s_add_u32 m0, s63, 1024
    s_nop 0
    buffer_load_dwordx4 v3, s[12:15], s61 offen lds
    s_add_u32 m0, s63, 2048
    s_nop 0
    buffer_load_dwordx4 v4, s[12:15], s61 offen lds
    s_add_u32 m0, s63, 3104
    s_nop 0
    buffer_load_dwordx4 v2, s[16:19], s61 offen lds
    s_add_u32 m0, s63, 4128
    s_nop 0
    buffer_load_dwordx4 v3, s[16:19], s61 offen lds
    s_add_u32 m0, s63, 5152
    s_nop 0
    buffer_load_dwordx4 v4, s[16:19], s61 offen lds
    v_bfe_u32 v10, v0, 4, 1
    v_mul_u32_u24 v10, 3104, v10
    v_lshrrev_b32 v11, 5, v0
    v_bfe_u32 v12, v0, 2, 2
    v_lshl_add_u32 v11, v11, 3, v12
    v_mul_u32_u24 v11, 192, v11
    v_add_u32 v10, v10, v11
    v_and_b32 v11, 1, v0
    v_bfe_u32 v12, v0, 1, 1
    v_lshl_add_u32 v11, v11, 1, v12
    v_lshl_add_u32 v6, v11, 3, v10
    v_add_u32 v6, s63, v6
    v_bfe_u32 v10, v0, 2, 2
    v_lshrrev_b32 v11, 4, v0
    v_cmp_eq_u32 vcc, v10, v11
    v_mov_b32 v11, 0x3f803f80
    s_nop 0
    v_cndmask_b32 v136, 0, v11, vcc
    v_cndmask_b32 v137, 0, v11, vcc
    v_cndmask_b32 v138, 0, v11, vcc
    v_cndmask_b32 v139, 0, v11, vcc
    v_bfe_u32 v104, v0, 1, 3
    s_lshl_b32 s47, s41, 3
    v_add_u32 v104, s47, v104
    v_mul_u32_u24 v105, 1040, v104
    v_and_b32 v101, 1, v0
    v_lshl_add_u32 v105, v101, 6, v105
    v_lshrrev_b32 v101, 4, v0
    v_lshl_add_u32 v105, v101, 4, v105
    v_add_u32 v105, 122976, v105
    s_lshl_b32 s47, s41, 2
    s_add_u32 s47, s47, 156320
    v_mov_b32 v103, s47
    v_mov_b32 v108, 0x3f803f80
    v_mov_b32 v109, 0x3f803f80
    v_mov_b32 v110, 0x3f803f80
    v_mov_b32 v111, 0x3f803f80
    v_lshlrev_b32 v106, 2, v104
    v_add_u32 v106, 161632, v106
    v_lshlrev_b32 v107, 4, v104
    v_add_u32 v107, 161888, v107
    s_mov_b32 s56, 0xaaaaaaaa
    s_mov_b32 s57, 0xaaaaaaaa
    s_mov_b32 s58, 0xcccccccc
    s_mov_b32 s59, 0xcccccccc
    ds_read_b32 v100, v103
    s_waitcnt lgkmcnt(0)
    v_cmp_gt_u32 vcc, 1, v100
    s_cbranch_vccnz Lst_1199
Lrt_1200:
    s_setprio 3
    ds_read_b128 v[60:63], v105 offset:0
    ds_read_b128 v[64:67], v105 offset:128
    ds_read_b128 v[68:71], v105 offset:256
    ds_read_b128 v[72:75], v105 offset:384
    ds_read_b128 v[76:79], v105 offset:512
    ds_read_b128 v[80:83], v105 offset:640
    ds_read_b128 v[84:87], v105 offset:768
    ds_read_b128 v[88:91], v105 offset:896
    s_waitcnt lgkmcnt(7)
    v_mfma_f32_16x16x32_bf16 v[92:95], v[60:63], v[60:63], 0
    v_mfma_f32_16x16x32_bf16 v[96:99], v[60:63], v[108:111], 0
    s_waitcnt lgkmcnt(6)
    v_mfma_f32_16x16x32_bf16 v[92:95], v[64:67], v[64:67], v[92:95]
    v_mfma_f32_16x16x32_bf16 v[96:99], v[64:67], v[108:111], v[96:99]
    s_waitcnt lgkmcnt(5)
    v_mfma_f32_16x16x32_bf16 v[92:95], v[68:71], v[68:71], v[92:95]
    v_mfma_f32_16x16x32_bf16 v[96:99], v[68:71], v[108:111], v[96:99]
    s_waitcnt lgkmcnt(4)
    v_mfma_f32_16x16x32_bf16 v[92:95], v[72:75], v[72:75], v[92:95]
    v_mfma_f32_16x16x32_bf16 v[96:99], v[72:75], v[108:111], v[96:99]
    s_waitcnt lgkmcnt(3)
    v_mfma_f32_16x16x32_bf16 v[92:95], v[76:79], v[76:79], v[92:95]
    v_mfma_f32_16x16x32_bf16 v[96:99], v[76:79], v[108:111], v[96:99]
    s_waitcnt lgkmcnt(2)
    v_mfma_f32_16x16x32_bf16 v[92:95], v[80:83], v[80:83], v[92:95]
    v_mfma_f32_16x16x32_bf16 v[96:99], v[80:83], v[108:111], v[96:99]
    s_waitcnt lgkmcnt(1)
    v_mfma_f32_16x16x32_bf16 v[92:95], v[84:87], v[84:87], v[92:95]
    v_mfma_f32_16x16x32_bf16 v[96:99], v[84:87], v[108:111], v[96:99]
    s_waitcnt lgkmcnt(0)
    v_mfma_f32_16x16x32_bf16 v[92:95], v[88:91], v[88:91], v[92:95]
    v_mfma_f32_16x16x32_bf16 v[96:99], v[88:91], v[108:111], v[96:99]
    s_nop 10
    v_cndmask_b32 v92, v92, v93, s[56:57]
    v_cndmask_b32 v94, v94, v95, s[56:57]
    v_cndmask_b32 v92, v92, v94, s[58:59]
    v_cndmask_b32 v96, v96, v97, s[56:57]
    v_cndmask_b32 v98, v98, v99, s[56:57]
    v_cndmask_b32 v96, v96, v98, s[58:59]
    v_add_f32_dpp v92, v92, v92 quad_perm:[1,0,3,2] row_mask:0xf bank_mask:0xf
    s_nop 0
    v_add_f32_dpp v96, v96, v96 quad_perm:[1,0,3,2] row_mask:0xf bank_mask:0xf
    v_mul_f32 v96, 0x3b000000, v96
    v_mul_f32 v100, v96, v96
    v_mul_f32 v92, 0x3b000000, v92
    v_sub_f32 v92, v92, v100
    v_max_f32 v92, 0, v92
    v_cvt_pk_bf16_f32 v92, v92, v92
    v_and_b32 v92, 0xffff0000, v92
    v_add_f32 v92, 0x3727c5ac, v92
    v_cvt_pk_bf16_f32 v92, v92, v92
    v_and_b32 v92, 0xffff0000, v92
    v_sqrt_f32 v92, v92
    s_nop 0
    v_cvt_pk_bf16_f32 v92, v92, v92
    v_and_b32 v92, 0xffff0000, v92
    v_cvt_pk_bf16_f32 v96, v96, v96
    v_and_b32 v96, 0xffff0000, v96
    v_rcp_f32 v100, v92
    v_cvt_pk_bf16_f32 v60, -v96, -v96
    v_mul_f32 v63, v92, v92
    v_mul_f32 v62, 0xbfb8aa3b, v100
    v_mul_f32 v100, 0x36000000, v100
    v_mov_b32 v61, v60
    v_and_b32 v62, 0xffffff00, v62
    v_mul_f32 v102, -v96, v100
    s_mov_b32 exec_lo, 0x00f0000f
    s_mov_b32 exec_hi, 0xf0000f00
    ds_write2_b32 v106, v100, v102 offset0:0 offset1:32
    ds_write_b128 v107, v[60:63]
    s_mov_b64 exec, -1
    v_mov_b32 v101, 1
    ds_write_b32 v103, v101 offset:160
    s_setprio 2
    s_add_u32 s61, s60, 44032
    s_add_u32 m0, s63, 6176
    s_nop 0
    buffer_load_dwordx4 v2, s[12:15], s61 offen lds
    s_add_u32 m0, s63, 7200
    s_nop 0
    buffer_load_dwordx4 v3, s[12:15], s61 offen lds
    s_add_u32 m0, s63, 8224
    s_nop 0
    buffer_load_dwordx4 v4, s[12:15], s61 offen lds
    s_add_u32 m0, s63, 9280
    s_nop 0
    buffer_load_dwordx4 v2, s[16:19], s61 offen lds
    s_add_u32 m0, s63, 10304
    s_nop 0
    buffer_load_dwordx4 v3, s[16:19], s61 offen lds
    s_add_u32 m0, s63, 11328
    s_nop 0
    buffer_load_dwordx4 v4, s[16:19], s61 offen lds
    s_waitcnt vmcnt(6)
    ds_read_b64_tr_b16 v[16:17], v6 offset:0
    ds_read_b64_tr_b16 v[18:19], v6 offset:768
    ds_read_b64_tr_b16 v[20:21], v6 offset:32
    ds_read_b64_tr_b16 v[22:23], v6 offset:800
    ds_read_b64_tr_b16 v[24:25], v6 offset:64
    ds_read_b64_tr_b16 v[26:27], v6 offset:832
    ds_read_b64_tr_b16 v[28:29], v6 offset:96
    ds_read_b64_tr_b16 v[30:31], v6 offset:864
    ds_read_b64_tr_b16 v[32:33], v6 offset:128
    ds_read_b64_tr_b16 v[34:35], v6 offset:896
    ds_read_b64_tr_b16 v[36:37], v6 offset:160
    ds_read_b64_tr_b16 v[38:39], v6 offset:928
    s_waitcnt lgkmcnt(10)
    v_mfma_f32_16x16x32_bf16 v[112:115], v[136:139], v[16:19], 0
    s_waitcnt lgkmcnt(8)
    v_mfma_f32_16x16x32_bf16 v[116:119], v[136:139], v[20:23], 0
    s_waitcnt lgkmcnt(6)
    v_mfma_f32_16x16x32_bf16 v[120:123], v[136:139], v[24:27], 0
    s_waitcnt lgkmcnt(4)
    v_mfma_f32_16x16x32_bf16 v[124:127], v[136:139], v[28:31], 0
    s_waitcnt lgkmcnt(2)
    v_mfma_f32_16x16x32_bf16 v[128:131], v[136:139], v[32:35], 0
    s_waitcnt lgkmcnt(0)
    v_mfma_f32_16x16x32_bf16 v[132:135], v[136:139], v[36:39], 0
    s_add_u32 s61, s60, 88064
    s_add_u32 m0, s63, 12352
    s_nop 0
    buffer_load_dwordx4 v2, s[12:15], s61 offen lds
    s_add_u32 m0, s63, 13376
    s_nop 0
    buffer_load_dwordx4 v3, s[12:15], s61 offen lds
    s_add_u32 m0, s63, 14400
    s_nop 0
    buffer_load_dwordx4 v4, s[12:15], s61 offen lds
    s_add_u32 m0, s63, 15456
    s_nop 0
    buffer_load_dwordx4 v2, s[16:19], s61 offen lds
    s_add_u32 m0, s63, 16480
    s_nop 0
    buffer_load_dwordx4 v3, s[16:19], s61 offen lds
    s_add_u32 m0, s63, 17504
    s_nop 0
    buffer_load_dwordx4 v4, s[16:19], s61 offen lds
    s_waitcnt vmcnt(6)
    ds_read_b64_tr_b16 v[16:17], v6 offset:6176
    ds_read_b64_tr_b16 v[18:19], v6 offset:6944
    ds_read_b64_tr_b16 v[20:21], v6 offset:6208
    ds_read_b64_tr_b16 v[22:23], v6 offset:6976
    ds_read_b64_tr_b16 v[24:25], v6 offset:6240
    ds_read_b64_tr_b16 v[26:27], v6 offset:7008
    ds_read_b64_tr_b16 v[28:29], v6 offset:6272
    ds_read_b64_tr_b16 v[30:31], v6 offset:7040
    ds_read_b64_tr_b16 v[32:33], v6 offset:6304
    ds_read_b64_tr_b16 v[34:35], v6 offset:7072
    ds_read_b64_tr_b16 v[36:37], v6 offset:6336
    ds_read_b64_tr_b16 v[38:39], v6 offset:7104
    s_waitcnt lgkmcnt(10)
    v_mfma_f32_16x16x32_bf16 v[112:115], v[136:139], v[16:19], v[112:115]
    s_waitcnt lgkmcnt(8)
    v_mfma_f32_16x16x32_bf16 v[116:119], v[136:139], v[20:23], v[116:119]
    s_waitcnt lgkmcnt(6)
    v_mfma_f32_16x16x32_bf16 v[120:123], v[136:139], v[24:27], v[120:123]
    s_waitcnt lgkmcnt(4)
    v_mfma_f32_16x16x32_bf16 v[124:127], v[136:139], v[28:31], v[124:127]
    s_waitcnt lgkmcnt(2)
    v_mfma_f32_16x16x32_bf16 v[128:131], v[136:139], v[32:35], v[128:131]
    s_waitcnt lgkmcnt(0)
    v_mfma_f32_16x16x32_bf16 v[132:135], v[136:139], v[36:39], v[132:135]
    s_add_u32 s61, s60, 132096
    s_add_u32 m0, s63, 18528
    s_nop 0
    buffer_load_dwordx4 v2, s[12:15], s61 offen lds
    s_add_u32 m0, s63, 19552
    s_nop 0
    buffer_load_dwordx4 v3, s[12:15], s61 offen lds
    s_add_u32 m0, s63, 20576
    s_nop 0
    buffer_load_dwordx4 v4, s[12:15], s61 offen lds
    s_add_u32 m0, s63, 21632
    s_nop 0
    buffer_load_dwordx4 v2, s[16:19], s61 offen lds
    s_add_u32 m0, s63, 22656
    s_nop 0
    buffer_load_dwordx4 v3, s[16:19], s61 offen lds
    s_add_u32 m0, s63, 23680
    s_nop 0
    buffer_load_dwordx4 v4, s[16:19], s61 offen lds
    s_waitcnt vmcnt(6)
    ds_read_b64_tr_b16 v[16:17], v6 offset:12352
    ds_read_b64_tr_b16 v[18:19], v6 offset:13120
    ds_read_b64_tr_b16 v[20:21], v6 offset:12384
    ds_read_b64_tr_b16 v[22:23], v6 offset:13152
    ds_read_b64_tr_b16 v[24:25], v6 offset:12416
    ds_read_b64_tr_b16 v[26:27], v6 offset:13184
    ds_read_b64_tr_b16 v[28:29], v6 offset:12448
    ds_read_b64_tr_b16 v[30:31], v6 offset:13216
    ds_read_b64_tr_b16 v[32:33], v6 offset:12480
    ds_read_b64_tr_b16 v[34:35], v6 offset:13248
    ds_read_b64_tr_b16 v[36:37], v6 offset:12512
    ds_read_b64_tr_b16 v[38:39], v6 offset:13280
    s_waitcnt lgkmcnt(10)
    v_mfma_f32_16x16x32_bf16 v[112:115], v[136:139], v[16:19], v[112:115]
    s_waitcnt lgkmcnt(8)
    v_mfma_f32_16x16x32_bf16 v[116:119], v[136:139], v[20:23], v[116:119]
    s_waitcnt lgkmcnt(6)
    v_mfma_f32_16x16x32_bf16 v[120:123], v[136:139], v[24:27], v[120:123]
    s_waitcnt lgkmcnt(4)
    v_mfma_f32_16x16x32_bf16 v[124:127], v[136:139], v[28:31], v[124:127]
    s_waitcnt lgkmcnt(2)
    v_mfma_f32_16x16x32_bf16 v[128:131], v[136:139], v[32:35], v[128:131]
    s_waitcnt lgkmcnt(0)
    v_mfma_f32_16x16x32_bf16 v[132:135], v[136:139], v[36:39], v[132:135]
    s_add_u32 s61, s60, 176128
    s_add_u32 m0, s63, 0
    s_nop 0
    buffer_load_dwordx4 v2, s[12:15], s61 offen lds
    s_add_u32 m0, s63, 1024
    s_nop 0
    buffer_load_dwordx4 v3, s[12:15], s61 offen lds
    s_add_u32 m0, s63, 2048
    s_nop 0
    buffer_load_dwordx4 v4, s[12:15], s61 offen lds
    s_add_u32 m0, s63, 3104
    s_nop 0
    buffer_load_dwordx4 v2, s[16:19], s61 offen lds
    s_add_u32 m0, s63, 4128
    s_nop 0
    buffer_load_dwordx4 v3, s[16:19], s61 offen lds
    s_add_u32 m0, s63, 5152
    s_nop 0
    buffer_load_dwordx4 v4, s[16:19], s61 offen lds
    s_waitcnt vmcnt(6)
    ds_read_b64_tr_b16 v[16:17], v6 offset:18528
    ds_read_b64_tr_b16 v[18:19], v6 offset:19296
    ds_read_b64_tr_b16 v[20:21], v6 offset:18560
    ds_read_b64_tr_b16 v[22:23], v6 offset:19328
    ds_read_b64_tr_b16 v[24:25], v6 offset:18592
    ds_read_b64_tr_b16 v[26:27], v6 offset:19360
    ds_read_b64_tr_b16 v[28:29], v6 offset:18624
    ds_read_b64_tr_b16 v[30:31], v6 offset:19392
    ds_read_b64_tr_b16 v[32:33], v6 offset:18656
    ds_read_b64_tr_b16 v[34:35], v6 offset:19424
    ds_read_b64_tr_b16 v[36:37], v6 offset:18688
    ds_read_b64_tr_b16 v[38:39], v6 offset:19456
    s_waitcnt lgkmcnt(10)
    v_mfma_f32_16x16x32_bf16 v[112:115], v[136:139], v[16:19], v[112:115]
    s_waitcnt lgkmcnt(8)
    v_mfma_f32_16x16x32_bf16 v[116:119], v[136:139], v[20:23], v[116:119]
    s_waitcnt lgkmcnt(6)
    v_mfma_f32_16x16x32_bf16 v[120:123], v[136:139], v[24:27], v[120:123]
    s_waitcnt lgkmcnt(4)
    v_mfma_f32_16x16x32_bf16 v[124:127], v[136:139], v[28:31], v[124:127]
    s_waitcnt lgkmcnt(2)
    v_mfma_f32_16x16x32_bf16 v[128:131], v[136:139], v[32:35], v[128:131]
    s_waitcnt lgkmcnt(0)
    v_mfma_f32_16x16x32_bf16 v[132:135], v[136:139], v[36:39], v[132:135]
    s_add_u32 s61, s60, 220160
    s_add_u32 m0, s63, 6176
    s_nop 0
    buffer_load_dwordx4 v2, s[12:15], s61 offen lds
    s_add_u32 m0, s63, 7200
    s_nop 0
    buffer_load_dwordx4 v3, s[12:15], s61 offen lds
    s_add_u32 m0, s63, 8224
    s_nop 0
    buffer_load_dwordx4 v4, s[12:15], s61 offen lds
    s_add_u32 m0, s63, 9280
    s_nop 0
    buffer_load_dwordx4 v2, s[16:19], s61 offen lds
    s_add_u32 m0, s63, 10304
    s_nop 0
    buffer_load_dwordx4 v3, s[16:19], s61 offen lds
    s_add_u32 m0, s63, 11328
    s_nop 0
    buffer_load_dwordx4 v4, s[16:19], s61 offen lds
    s_waitcnt vmcnt(6)
    ds_read_b64_tr_b16 v[16:17], v6 offset:0
    ds_read_b64_tr_b16 v[18:19], v6 offset:768
    ds_read_b64_tr_b16 v[20:21], v6 offset:32
    ds_read_b64_tr_b16 v[22:23], v6 offset:800
    ds_read_b64_tr_b16 v[24:25], v6 offset:64
    ds_read_b64_tr_b16 v[26:27], v6 offset:832
    ds_read_b64_tr_b16 v[28:29], v6 offset:96
    ds_read_b64_tr_b16 v[30:31], v6 offset:864
    ds_read_b64_tr_b16 v[32:33], v6 offset:128
    ds_read_b64_tr_b16 v[34:35], v6 offset:896
    ds_read_b64_tr_b16 v[36:37], v6 offset:160
    ds_read_b64_tr_b16 v[38:39], v6 offset:928
    s_waitcnt lgkmcnt(10)
    v_mfma_f32_16x16x32_bf16 v[112:115], v[136:139], v[16:19], v[112:115]
    s_waitcnt lgkmcnt(8)
    v_mfma_f32_16x16x32_bf16 v[116:119], v[136:139], v[20:23], v[116:119]
    s_waitcnt lgkmcnt(6)
    v_mfma_f32_16x16x32_bf16 v[120:123], v[136:139], v[24:27], v[120:123]
    s_waitcnt lgkmcnt(4)
    v_mfma_f32_16x16x32_bf16 v[124:127], v[136:139], v[28:31], v[124:127]
    s_waitcnt lgkmcnt(2)
    v_mfma_f32_16x16x32_bf16 v[128:131], v[136:139], v[32:35], v[128:131]
    s_waitcnt lgkmcnt(0)
    v_mfma_f32_16x16x32_bf16 v[132:135], v[136:139], v[36:39], v[132:135]
    s_add_u32 s61, s60, 264192
    s_add_u32 m0, s63, 12352
    s_nop 0
    buffer_load_dwordx4 v2, s[12:15], s61 offen lds
    s_add_u32 m0, s63, 13376
    s_nop 0
    buffer_load_dwordx4 v3, s[12:15], s61 offen lds
    s_add_u32 m0, s63, 14400
    s_nop 0
    buffer_load_dwordx4 v4, s[12:15], s61 offen lds
    s_add_u32 m0, s63, 15456
    s_nop 0
    buffer_load_dwordx4 v2, s[16:19], s61 offen lds
    s_add_u32 m0, s63, 16480
    s_nop 0
    buffer_load_dwordx4 v3, s[16:19], s61 offen lds
    s_add_u32 m0, s63, 17504
    s_nop 0
    buffer_load_dwordx4 v4, s[16:19], s61 offen lds
    s_waitcnt vmcnt(6)
    ds_read_b64_tr_b16 v[16:17], v6 offset:6176
    ds_read_b64_tr_b16 v[18:19], v6 offset:6944
    ds_read_b64_tr_b16 v[20:21], v6 offset:6208
    ds_read_b64_tr_b16 v[22:23], v6 offset:6976
    ds_read_b64_tr_b16 v[24:25], v6 offset:6240
    ds_read_b64_tr_b16 v[26:27], v6 offset:7008
    ds_read_b64_tr_b16 v[28:29], v6 offset:6272
    ds_read_b64_tr_b16 v[30:31], v6 offset:7040
    ds_read_b64_tr_b16 v[32:33], v6 offset:6304
    ds_read_b64_tr_b16 v[34:35], v6 offset:7072
    ds_read_b64_tr_b16 v[36:37], v6 offset:6336
    ds_read_b64_tr_b16 v[38:39], v6 offset:7104
    s_waitcnt lgkmcnt(10)
    v_mfma_f32_16x16x32_bf16 v[112:115], v[136:139], v[16:19], v[112:115]
    s_waitcnt lgkmcnt(8)
    v_mfma_f32_16x16x32_bf16 v[116:119], v[136:139], v[20:23], v[116:119]
    s_waitcnt lgkmcnt(6)
    v_mfma_f32_16x16x32_bf16 v[120:123], v[136:139], v[24:27], v[120:123]
    s_waitcnt lgkmcnt(4)
    v_mfma_f32_16x16x32_bf16 v[124:127], v[136:139], v[28:31], v[124:127]
    s_waitcnt lgkmcnt(2)
    v_mfma_f32_16x16x32_bf16 v[128:131], v[136:139], v[32:35], v[128:131]
    s_waitcnt lgkmcnt(0)
    v_mfma_f32_16x16x32_bf16 v[132:135], v[136:139], v[36:39], v[132:135]
    s_add_u32 s61, s60, 308224
    s_add_u32 m0, s63, 18528
    s_nop 0
    buffer_load_dwordx4 v2, s[12:15], s61 offen lds
    s_add_u32 m0, s63, 19552
    s_nop 0
    buffer_load_dwordx4 v3, s[12:15], s61 offen lds
    s_add_u32 m0, s63, 20576
    s_nop 0
    buffer_load_dwordx4 v4, s[12:15], s61 offen lds
    s_add_u32 m0, s63, 21632
    s_nop 0
    buffer_load_dwordx4 v2, s[16:19], s61 offen lds
    s_add_u32 m0, s63, 22656
    s_nop 0
    buffer_load_dwordx4 v3, s[16:19], s61 offen lds
    s_add_u32 m0, s63, 23680
    s_nop 0
    buffer_load_dwordx4 v4, s[16:19], s61 offen lds
    s_waitcnt vmcnt(6)
    ds_read_b64_tr_b16 v[16:17], v6 offset:12352
    ds_read_b64_tr_b16 v[18:19], v6 offset:13120
    ds_read_b64_tr_b16 v[20:21], v6 offset:12384
    ds_read_b64_tr_b16 v[22:23], v6 offset:13152
    ds_read_b64_tr_b16 v[24:25], v6 offset:12416
    ds_read_b64_tr_b16 v[26:27], v6 offset:13184
    ds_read_b64_tr_b16 v[28:29], v6 offset:12448
    ds_read_b64_tr_b16 v[30:31], v6 offset:13216
    ds_read_b64_tr_b16 v[32:33], v6 offset:12480
    ds_read_b64_tr_b16 v[34:35], v6 offset:13248
    ds_read_b64_tr_b16 v[36:37], v6 offset:12512
    ds_read_b64_tr_b16 v[38:39], v6 offset:13280
    s_waitcnt lgkmcnt(10)
    v_mfma_f32_16x16x32_bf16 v[112:115], v[136:139], v[16:19], v[112:115]
    s_waitcnt lgkmcnt(8)
    v_mfma_f32_16x16x32_bf16 v[116:119], v[136:139], v[20:23], v[116:119]
    s_waitcnt lgkmcnt(6)
    v_mfma_f32_16x16x32_bf16 v[120:123], v[136:139], v[24:27], v[120:123]
    s_waitcnt lgkmcnt(4)
    v_mfma_f32_16x16x32_bf16 v[124:127], v[136:139], v[28:31], v[124:127]
    s_waitcnt lgkmcnt(2)
    v_mfma_f32_16x16x32_bf16 v[128:131], v[136:139], v[32:35], v[128:131]
    s_waitcnt lgkmcnt(0)
    v_mfma_f32_16x16x32_bf16 v[132:135], v[136:139], v[36:39], v[132:135]
    s_waitcnt vmcnt(0)
    ds_read_b64_tr_b16 v[16:17], v6 offset:18528
    ds_read_b64_tr_b16 v[18:19], v6 offset:19296
    ds_read_b64_tr_b16 v[20:21], v6 offset:18560
    ds_read_b64_tr_b16 v[22:23], v6 offset:19328
    ds_read_b64_tr_b16 v[24:25], v6 offset:18592
    ds_read_b64_tr_b16 v[26:27], v6 offset:19360
    ds_read_b64_tr_b16 v[28:29], v6 offset:18624
    ds_read_b64_tr_b16 v[30:31], v6 offset:19392
    ds_read_b64_tr_b16 v[32:33], v6 offset:18656
    ds_read_b64_tr_b16 v[34:35], v6 offset:19424
    ds_read_b64_tr_b16 v[36:37], v6 offset:18688
    ds_read_b64_tr_b16 v[38:39], v6 offset:19456
    s_waitcnt lgkmcnt(10)
    v_mfma_f32_16x16x32_bf16 v[112:115], v[136:139], v[16:19], v[112:115]
    s_waitcnt lgkmcnt(8)
    v_mfma_f32_16x16x32_bf16 v[116:119], v[136:139], v[20:23], v[116:119]
    s_waitcnt lgkmcnt(6)
    v_mfma_f32_16x16x32_bf16 v[120:123], v[136:139], v[24:27], v[120:123]
    s_waitcnt lgkmcnt(4)
    v_mfma_f32_16x16x32_bf16 v[124:127], v[136:139], v[28:31], v[124:127]
    s_waitcnt lgkmcnt(2)
    v_mfma_f32_16x16x32_bf16 v[128:131], v[136:139], v[32:35], v[128:131]
    s_waitcnt lgkmcnt(0)
    v_mfma_f32_16x16x32_bf16 v[132:135], v[136:139], v[36:39], v[132:135]
    v_lshlrev_b32 v10, 2, v0
    v_add_u32 v11, s63, v10
    ds_write_b32 v11, v112 offset:0
    s_nop 0
    ds_write_b32 v11, v116 offset:256
    s_nop 0
    ds_write_b32 v11, v120 offset:512
    s_nop 0
    ds_write_b32 v11, v124 offset:768
    s_nop 0
    ds_write_b32 v11, v128 offset:1024
    s_nop 0
    ds_write_b32 v11, v132 offset:1280
    s_lshl_b32 s47, s41, 2
    s_add_u32 s47, s47, 156400
    v_mov_b32 v12, s47
    v_mov_b32 v9, 1
    ds_write_b32 v12, v9
    s_mov_b32 s20, s82
    s_mov_b32 s21, s83
    s_mov_b32 s22, 16777216
    s_mov_b32 s23, 0x00020000
    v_mov_b32 v12, 156340
    ds_read_b32 v13, v12
    s_waitcnt lgkmcnt(0)
    v_cmp_gt_u32 vcc, 1, v13
    s_cbranch_vccnz Lst_1202
Lrt_1203:
    ds_read_b32 v13, v12 offset:44
    s_waitcnt lgkmcnt(0)
    v_readfirstlane_b32 s44, v13
    v_and_b32 v12, 3, v0
    v_lshlrev_b32 v12, 2, v12
    v_add_u32 v12, 156400, v12
    ds_read_b32 v9, v12
    s_waitcnt lgkmcnt(0)
    v_cmp_gt_u32 vcc, 1, v9
    s_cbranch_vccnz Lst_1205
Lrt_1206:
    s_lshr_b32 s47, s41, 1
    s_mul_i32 s47, s47, 61440
    s_and_b32 s48, s41, 1
    s_mul_i32 s48, s48, 768
    s_add_u32 s47, s47, s48
    v_add_u32 v11, s47, v10
    ds_read_b32 v16, v11 offset:0
    ds_read_b32 v17, v11 offset:30720
    ds_read_b32 v18, v11 offset:256
    ds_read_b32 v19, v11 offset:30976
    ds_read_b32 v20, v11 offset:512
    ds_read_b32 v21, v11 offset:31232
    v_mov_b32 v9, 8
    ds_write_b32 v8, v9
    s_lshl_b32 s47, s50, 12
    s_mul_i32 s48, s41, 768
    s_add_u32 s47, s47, s48
    s_add_u32 s47, s47, 15007744
    s_waitcnt lgkmcnt(5)
    v_add_f32 v16, v16, v17
    v_and_b32 v17, 0xffff0000, v16
    v_sub_f32 v16, v16, v17
    v_cvt_pk_bf16_f32 v16, v17, v16
    buffer_store_dword v16, v10, s[20:23], s47 offen offset:0 sc1
    s_waitcnt lgkmcnt(3)
    v_add_f32 v18, v18, v19
    v_and_b32 v19, 0xffff0000, v18
    v_sub_f32 v18, v18, v19
    v_cvt_pk_bf16_f32 v18, v19, v18
    buffer_store_dword v18, v10, s[20:23], s47 offen offset:256 sc1
    s_waitcnt lgkmcnt(1)
    v_add_f32 v20, v20, v21
    v_and_b32 v21, 0xffff0000, v20
    v_sub_f32 v20, v20, v21
    v_cvt_pk_bf16_f32 v20, v21, v20
    buffer_store_dword v20, v10, s[20:23], s47 offen offset:512 sc1
    s_lshl_b32 s47, s50, 8
    s_add_u32 s56, s47, 14749696
    s_add_u32 s56, s82, s56
    s_addc_u32 s57, s83, 0
    s_mov_b32 s55, 1
    s_waitcnt vmcnt(0)
    s_atomic_add s55, s[56:57], 0 glc
    s_waitcnt lgkmcnt(0)
    s_sub_u32 s55, s55, s44
    s_cmp_ge_u32 s55, 64
    s_cbranch_scc1 Las_1208
Lar_1209:
    s_waitcnt vmcnt(0) lgkmcnt(0)
Llastb_1211:
    s_mov_b32 s62, 0x7f000000
    v_mov_b32 v12, 0
    v_mov_b32 v13, 0
    s_waitcnt vmcnt(0) lgkmcnt(0)
    s_branch Lcjoin_1119
Llast_1198:
    v_bfe_u32 v104, v0, 1, 3
    s_lshl_b32 s47, s41, 3
    v_add_u32 v104, s47, v104
    v_mul_u32_u24 v105, 1040, v104
    v_and_b32 v101, 1, v0
    v_lshl_add_u32 v105, v101, 6, v105
    v_lshrrev_b32 v101, 4, v0
    v_lshl_add_u32 v105, v101, 4, v105
    v_add_u32 v105, 122976, v105
    s_lshl_b32 s47, s41, 2
    s_add_u32 s47, s47, 156320
    v_mov_b32 v103, s47
    v_mov_b32 v108, 0x3f803f80
    v_mov_b32 v109, 0x3f803f80
    v_mov_b32 v110, 0x3f803f80
    v_mov_b32 v111, 0x3f803f80
    v_lshlrev_b32 v106, 2, v104
    v_add_u32 v106, 161632, v106
    v_lshlrev_b32 v107, 4, v104
    v_add_u32 v107, 161888, v107
    s_mov_b32 s56, 0xaaaaaaaa
    s_mov_b32 s57, 0xaaaaaaaa
    s_mov_b32 s58, 0xcccccccc
    s_mov_b32 s59, 0xcccccccc
    ds_read_b32 v100, v103
    s_waitcnt lgkmcnt(0)
    v_cmp_gt_u32 vcc, 1, v100
    s_cbranch_vccnz Lst_1212
Lrt_1213:
    s_setprio 3
    ds_read_b128 v[60:63], v105 offset:0
    ds_read_b128 v[64:67], v105 offset:128
    ds_read_b128 v[68:71], v105 offset:256
    ds_read_b128 v[72:75], v105 offset:384
    ds_read_b128 v[76:79], v105 offset:512
    ds_read_b128 v[80:83], v105 offset:640
    ds_read_b128 v[84:87], v105 offset:768
    ds_read_b128 v[88:91], v105 offset:896
    s_waitcnt lgkmcnt(7)
    v_mfma_f32_16x16x32_bf16 v[92:95], v[60:63], v[60:63], 0
    v_mfma_f32_16x16x32_bf16 v[96:99], v[60:63], v[108:111], 0
    s_waitcnt lgkmcnt(6)
    v_mfma_f32_16x16x32_bf16 v[92:95], v[64:67], v[64:67], v[92:95]
    v_mfma_f32_16x16x32_bf16 v[96:99], v[64:67], v[108:111], v[96:99]
    s_waitcnt lgkmcnt(5)
    v_mfma_f32_16x16x32_bf16 v[92:95], v[68:71], v[68:71], v[92:95]
    v_mfma_f32_16x16x32_bf16 v[96:99], v[68:71], v[108:111], v[96:99]
    s_waitcnt lgkmcnt(4)
    v_mfma_f32_16x16x32_bf16 v[92:95], v[72:75], v[72:75], v[92:95]
    v_mfma_f32_16x16x32_bf16 v[96:99], v[72:75], v[108:111], v[96:99]
    s_waitcnt lgkmcnt(3)
    v_mfma_f32_16x16x32_bf16 v[92:95], v[76:79], v[76:79], v[92:95]
    v_mfma_f32_16x16x32_bf16 v[96:99], v[76:79], v[108:111], v[96:99]
    s_waitcnt lgkmcnt(2)
    v_mfma_f32_16x16x32_bf16 v[92:95], v[80:83], v[80:83], v[92:95]
    v_mfma_f32_16x16x32_bf16 v[96:99], v[80:83], v[108:111], v[96:99]
    s_waitcnt lgkmcnt(1)
    v_mfma_f32_16x16x32_bf16 v[92:95], v[84:87], v[84:87], v[92:95]
    v_mfma_f32_16x16x32_bf16 v[96:99], v[84:87], v[108:111], v[96:99]
    s_waitcnt lgkmcnt(0)
    v_mfma_f32_16x16x32_bf16 v[92:95], v[88:91], v[88:91], v[92:95]
    v_mfma_f32_16x16x32_bf16 v[96:99], v[88:91], v[108:111], v[96:99]
    s_nop 10
    v_cndmask_b32 v92, v92, v93, s[56:57]
    v_cndmask_b32 v94, v94, v95, s[56:57]
    v_cndmask_b32 v92, v92, v94, s[58:59]
    v_cndmask_b32 v96, v96, v97, s[56:57]
    v_cndmask_b32 v98, v98, v99, s[56:57]
    v_cndmask_b32 v96, v96, v98, s[58:59]
    v_add_f32_dpp v92, v92, v92 quad_perm:[1,0,3,2] row_mask:0xf bank_mask:0xf
    s_nop 0
    v_add_f32_dpp v96, v96, v96 quad_perm:[1,0,3,2] row_mask:0xf bank_mask:0xf
    v_mul_f32 v96, 0x3b000000, v96
    v_mul_f32 v100, v96, v96
    v_mul_f32 v92, 0x3b000000, v92
    v_sub_f32 v92, v92, v100
    v_max_f32 v92, 0, v92
    v_cvt_pk_bf16_f32 v92, v92, v92
    v_and_b32 v92, 0xffff0000, v92
    v_add_f32 v92, 0x3727c5ac, v92
    v_cvt_pk_bf16_f32 v92, v92, v92
    v_and_b32 v92, 0xffff0000, v92
    v_sqrt_f32 v92, v92
    s_nop 0
    v_cvt_pk_bf16_f32 v92, v92, v92
    v_and_b32 v92, 0xffff0000, v92
    v_cvt_pk_bf16_f32 v96, v96, v96
    v_and_b32 v96, 0xffff0000, v96
    v_rcp_f32 v100, v92
    v_cvt_pk_bf16_f32 v60, -v96, -v96
    v_mul_f32 v63, v92, v92
    v_mul_f32 v62, 0xbfb8aa3b, v100
    v_mul_f32 v100, 0x36000000, v100
    v_mov_b32 v61, v60
    v_and_b32 v62, 0xffffff00, v62
    v_mul_f32 v102, -v96, v100
    s_mov_b32 exec_lo, 0x00f0000f
    s_mov_b32 exec_hi, 0xf0000f00
    ds_write2_b32 v106, v100, v102 offset0:0 offset1:32
    ds_write_b128 v107, v[60:63]
    s_mov_b64 exec, -1
    v_mov_b32 v101, 1
    ds_write_b32 v103, v101 offset:160
    s_setprio 2
    v_mov_b32 v9, 8
    ds_write_b32 v8, v9
    s_waitcnt lgkmcnt(0)
    s_branch Llastb_1211
Lst_1199:
    s_mov_b32 s46, 200000
Llp_1201:
    s_sleep 1
    ds_read_b32 v100, v103
    s_waitcnt lgkmcnt(0)
    v_cmp_gt_u32 vcc, 1, v100
    s_cbranch_vccz Lrt_1200
    s_sub_u32 s46, s46, 1
    s_cbranch_scc0 Llp_1201
    s_branch Lrt_1200
Lst_1202:
    s_mov_b32 s46, 200000
Llp_1204:
    s_sleep 1
    ds_read_b32 v13, v12
    s_waitcnt lgkmcnt(0)
    v_cmp_gt_u32 vcc, 1, v13
    s_cbranch_vccz Lrt_1203
    s_sub_u32 s46, s46, 1
    s_cbranch_scc0 Llp_1204
    s_branch Lrt_1203
Lst_1205:
    s_mov_b32 s46, 200000
Llp_1207:
    s_sleep 1
    ds_read_b32 v9, v12
    s_waitcnt lgkmcnt(0)
    v_cmp_gt_u32 vcc, 1, v9
    s_cbranch_vccz Lrt_1206
    s_sub_u32 s46, s46, 1
    s_cbranch_scc0 Llp_1207
    s_branch Lrt_1206
Las_1208:
    s_mov_b32 s46, 60000
Lap_1210:
    s_sleep 4
    s_mov_b32 s55, 1
    s_atomic_add s55, s[56:57], 0 glc
    s_waitcnt lgkmcnt(0)
    s_sub_u32 s55, s55, s44
    s_cmp_lt_u32 s55, 64
    s_cbranch_scc1 Lar_1209
    s_sub_u32 s46, s46, 1
    s_cbranch_scc0 Lap_1210
    s_branch Lar_1209
Lst_1212:
    s_mov_b32 s46, 200000
Llp_1214:
    s_sleep 1
    ds_read_b32 v100, v103
    s_waitcnt lgkmcnt(0)
    v_cmp_gt_u32 vcc, 1, v100
    s_cbranch_vccz Lrt_1213
    s_sub_u32 s46, s46, 1
    s_cbranch_scc0 Llp_1214
    s_branch Lrt_1213
Lend_1:
    s_endpgm
.fill (41472 - (. - parallel_sum__spectral_gfnet__glu_gated_swiglu__prompt_kernel)) / 4, 4, 0xbf810000
.section .rodata,"a"
.p2align 6
.amdhsa_kernel parallel_sum__spectral_gfnet__glu_gated_swiglu__prompt_kernel
  .amdhsa_next_free_vgpr 168
  .amdhsa_next_free_sgpr 102
  .amdhsa_accum_offset 168
  .amdhsa_group_segment_fixed_size 0
  .amdhsa_kernarg_size 80
  .amdhsa_user_sgpr_count 2
  .amdhsa_user_sgpr_kernarg_segment_ptr 1
  .amdhsa_system_sgpr_workgroup_id_x 1
.end_amdhsa_kernel
```
